```python
import torch

def _softmax(x, axis=-1):
    return torch.softmax(x, dim=axis)
def _gelu(x):
    return torch.nn.functional.gelu(x, approximate="tanh")
def _silu(x):
    return torch.nn.functional.silu(x)
def _sigmoid(x):
    return torch.sigmoid(x)
def _layernorm(x, axis=-1, eps=1e-5):
    m = x.mean(dim=axis, keepdim=True)
    v = x.var(dim=axis, keepdim=True, unbiased=False)
    return (x - m) / torch.sqrt(v + eps)
def _scatter_add(tgt, idx, src, axis=0):
    return tgt.clone().index_add_(axis, idx, src)
def _segment_sum(src, seg, n):
    out = torch.zeros((n,) + src.shape[1:], dtype=src.dtype)
    return out.index_add_(0, seg, src)
def _pad(x, pw):
    flat = tuple(v for pair in reversed(pw) for v in pair)
    return torch.nn.functional.pad(x, flat)

kernel_name = 'parallel_sum__mha_block__dense_activation_relu__prompt'

def setup_inputs():

    _w = (lambda a: (lambda t: t.to(torch.bfloat16) if t.is_floating_point() else t)(torch.as_tensor(a)))
    def _A_setup():
        B, S, D, H = 1, 2048, 448, 16
        return {
            "x": _w((lambda *s: torch.randn(*s, dtype=torch.bfloat16) * 0.05)(B, S, D)),
            "wqkv": _w((lambda *s: torch.randn(*s, dtype=torch.bfloat16) * 0.2)(D, 3 * D)),
            "wo": _w((lambda *s: torch.randn(*s, dtype=torch.bfloat16) * 0.1)(D, D)),
        }
    _A_in = _A_setup()

    def _B_setup():
        B, S, D, Dff = 1, 2048, 448, 1792
        return {
            "x": _w((lambda *s: torch.randn(*s, dtype=torch.bfloat16) * 0.05)(B, S, D)),
            "w1": _w((lambda *s: torch.randn(*s, dtype=torch.bfloat16) * 0.2)(D, Dff)),
            "w2": _w((lambda *s: torch.randn(*s, dtype=torch.bfloat16) * 0.2)(Dff, D)),
        }
    _B_in = _B_setup()

    return {
        "A_x": _A_in["x"],
        "A_wqkv": _A_in["wqkv"],
        "A_wo": _A_in["wo"],
        "B_x": _B_in["x"],
        "B_w1": _B_in["w1"],
        "B_w2": _B_in["w2"],
    }

def reference(A_x, A_wqkv, A_wo, B_x, B_w1, B_w2):
    def _A_ref(x, wqkv, wo):
        B, S, D = x.shape
        H = 16
        Dh = D // H
        qkv = (lambda x, *d: x.permute(*d))((x @ wqkv).reshape(B, S, 3, H, Dh), 2, 0, 3, 1, 4)
        q, k, v = qkv[0], qkv[1], qkv[2]
        scores = torch.einsum("bhqd,bhkd->bhqk", q, k) * (Dh ** -0.5)
        p = _softmax(scores, axis=-1)
        o = torch.einsum("bhqk,bhkd->bhqd", p, v)
        return (lambda x, *d: x.permute(*d))(o, 0, 2, 1, 3).reshape(B, S, D) @ wo

    def _B_ref(x, w1, w2):
        h = torch.einsum("bsd,df->bsf", x, w1)
        zero = torch.zeros_like(h)
        h = torch.maximum(h, zero)
        return torch.einsum("bsf,fd->bsd", h, w2)

    x = A_x
    xn = _layernorm(x, axis=-1)
    return x + _A_ref(xn, A_wqkv, A_wo) + _B_ref(xn, B_w1, B_w2)
```

```asm
; @launch grid=(256,1,1) block=(512,1,1) lds=154688
.amdgcn_target "amdgcn-amd-amdhsa--gfx950"
.text
.globl parallel_sum__mha_block__dense_activation_relu__prompt_kernel
.p2align 8
.type parallel_sum__mha_block__dense_activation_relu__prompt_kernel,@function
parallel_sum__mha_block__dense_activation_relu__prompt_kernel:
    s_cmp_ge_u32 s2, 256
    s_cbranch_scc1 K_END
    s_load_dwordx4 s[40:43], s[0:1], 0
    s_load_dwordx2 s[44:45], s[0:1], 16
    s_load_dwordx8 s[48:55], s[0:1], 32
    s_load_dwordx2 s[46:47], s[0:1], 64
    v_lshrrev_b32 v1, 6, v0
    v_and_b32 v0, 63, v0
    v_readfirstlane_b32 s20, v1
    s_and_b32 s36, s2, 7
    s_lshr_b32 s37, s2, 3
    s_lshr_b32 s21, s36, 1
    s_lshl_b32 s21, s21, 2
    s_and_b32 s23, s37, 3
    s_add_u32 s21, s21, s23
    s_lshl_b32 s21, s21, 2
    s_and_b32 s22, s36, 1
    s_lshl_b32 s22, s22, 3
    s_lshr_b32 s23, s37, 2
    s_add_u32 s22, s22, s23
    s_cmp_ge_u32 s20, 4
    s_cbranch_scc1 K_HELPER
    s_and_b32 s23, s37, 7
    s_cmp_lg_u32 s23, 0
    s_cbranch_scc1 K_COMP
    s_getpc_b64 s[60:61]
K_PC:
    s_sub_u32 s60, s60, K_PC-parallel_sum__mha_block__dense_activation_relu__prompt_kernel
    s_subb_u32 s61, s61, 0
    s_lshl_b32 s23, s20, 7
    v_lshl_add_u32 v2, v0, 9, s23
    v_min_u32 v2, K_LAST-parallel_sum__mha_block__dense_activation_relu__prompt_kernel-4, v2
    global_load_dword v12, v2, s[60:61]
    s_branch K_COMP
K_HELPER:
    s_waitcnt lgkmcnt(0)
    s_mov_b32 s4, s40
    s_and_b32 s5, s41, 0xffff
    s_mov_b32 s6, 1835008
    s_mov_b32 s7, 0x00020000
    s_mov_b32 s8, s42
    s_and_b32 s9, s43, 0xffff
    s_mov_b32 s10, 1204224
    s_mov_b32 s11, 0x00020000
    s_sub_u32 s20, s20, 4
    s_add_u32 s29, s21, s20
    s_mul_i32 s29, s29, 28672
    v_lshrrev_b32 v4, 3, v0
    v_mul_u32_u24 v7, 896, v4
    v_lshrrev_b32 v5, 4, v0
    v_and_b32 v6, 7, v0
    v_xor_b32 v6, v5, v6
    v_lshl_add_u32 v12, v6, 4, v7
    v_xor_b32 v6, 4, v6
    v_lshl_add_u32 v13, v6, 4, v7
    s_mul_i32 s32, s22, 168
    s_mul_i32 s23, s20, 43008
    s_add_u32 s32, s32, s23
    s_lshl_b32 s28, s20, 12
    s_mul_i32 s25, s20, 3072
    s_add_u32 m0, s28, 12288
    s_add_u32 s23, s29, 0
    buffer_load_dwordx4 v12, s[4:7], s23 offen lds
    s_add_u32 m0, s28, 13312
    s_add_u32 s23, s29, 7168
    buffer_load_dwordx4 v13, s[4:7], s23 offen lds
    s_add_u32 m0, s28, 14336
    s_add_u32 s23, s29, 14336
    buffer_load_dwordx4 v12, s[4:7], s23 offen lds
    s_add_u32 m0, s28, 15360
    s_add_u32 s23, s29, 21504
    buffer_load_dwordx4 v13, s[4:7], s23 offen lds
    v_add_u32 v1, 0, v0
    v_mul_u32_u24 v2, 5462, v1
    v_lshrrev_b32 v2, 16, v2
    v_mul_u32_u24 v3, 12, v2
    v_sub_u32 v1, v1, v3
    v_lshrrev_b32 v3, 2, v1
    v_and_b32 v1, 3, v1
    v_lshlrev_b32 v1, 4, v1
    v_mad_u32_u24 v1, v3, 56, v1
    v_mul_u32_u24 v2, 2688, v2
    v_add_u32 v8, v1, v2
    v_add_u32 v1, 64, v0
    v_mul_u32_u24 v2, 5462, v1
    v_lshrrev_b32 v2, 16, v2
    v_mul_u32_u24 v3, 12, v2
    v_sub_u32 v1, v1, v3
    v_lshrrev_b32 v3, 2, v1
    v_and_b32 v1, 3, v1
    v_lshlrev_b32 v1, 4, v1
    v_mad_u32_u24 v1, v3, 56, v1
    v_mul_u32_u24 v2, 2688, v2
    v_add_u32 v9, v1, v2
    v_add_u32 v1, 128, v0
    v_mul_u32_u24 v2, 5462, v1
    v_lshrrev_b32 v2, 16, v2
    v_mul_u32_u24 v3, 12, v2
    v_sub_u32 v1, v1, v3
    v_lshrrev_b32 v3, 2, v1
    v_and_b32 v1, 3, v1
    v_lshlrev_b32 v1, 4, v1
    v_mad_u32_u24 v1, v3, 56, v1
    v_mul_u32_u24 v2, 2688, v2
    v_add_u32 v10, v1, v2
    s_add_u32 m0, s25, 0
    s_add_u32 s23, s32, 0
    buffer_load_dwordx4 v8, s[8:11], s23 offen lds
    s_add_u32 m0, s25, 1024
    s_add_u32 s23, s32, 0
    buffer_load_dwordx4 v9, s[8:11], s23 offen lds
    s_add_u32 m0, s25, 2048
    s_add_u32 s23, s32, 0
    buffer_load_dwordx4 v10, s[8:11], s23 offen lds
    s_add_u32 m0, s28, 40960
    s_add_u32 s23, s29, 128
    buffer_load_dwordx4 v12, s[4:7], s23 offen lds
    s_add_u32 m0, s28, 41984
    s_add_u32 s23, s29, 7296
    buffer_load_dwordx4 v13, s[4:7], s23 offen lds
    s_add_u32 m0, s28, 43008
    s_add_u32 s23, s29, 14464
    buffer_load_dwordx4 v12, s[4:7], s23 offen lds
    s_add_u32 m0, s28, 44032
    s_add_u32 s23, s29, 21632
    buffer_load_dwordx4 v13, s[4:7], s23 offen lds
    s_add_u32 m0, s25, 28672
    s_add_u32 s23, s32, 172032
    buffer_load_dwordx4 v8, s[8:11], s23 offen lds
    s_add_u32 m0, s25, 29696
    s_add_u32 s23, s32, 172032
    buffer_load_dwordx4 v9, s[8:11], s23 offen lds
    s_add_u32 m0, s25, 30720
    s_add_u32 s23, s32, 172032
    buffer_load_dwordx4 v10, s[8:11], s23 offen lds
    s_mov_b32 s16, s46
    s_and_b32 s17, s47, 0xffff
    s_mov_b32 s18, 19922944
    s_mov_b32 s19, 0x00020000
    s_mov_b32 s12, s48
    s_and_b32 s13, s49, 0xffff
    s_mov_b32 s14, 1605632
    s_mov_b32 s15, 0x00020000
    v_lshrrev_b32 v1, 5, v0
    v_lshlrev_b32 v1, 3, v1
    v_bfe_u32 v2, v0, 2, 2
    v_add_u32 v1, v1, v2
    v_bfe_u32 v2, v0, 4, 1
    v_lshlrev_b32 v17, 5, v2
    v_and_b32 v2, 3, v0
    v_lshl_add_u32 v17, v2, 3, v17
    v_mul_u32_u24 v16, 192, v1
    v_add_u32 v16, v16, v17
    v_lshl_add_u32 v17, v1, 7, v17
    v_bfe_u32 v2, v0, 3, 1
    v_lshl_add_u32 v17, v2, 6, v17
    v_xor_b32 v18, 64, v17
    s_mul_i32 s23, s20, 3072
    v_add_u32 v16, s23, v16
    v_bfe_u32 v1, v0, 2, 1
    v_bfe_u32 v2, v0, 4, 1
    v_xor_b32 v1, v1, v2
    v_and_b32 v3, 3, v0
    v_lshlrev_b32 v3, 4, v3
    v_lshl_add_u32 v3, v1, 6, v3
    v_mul_u32_u24 v4, 3584, v4
    v_add_u32 v14, v4, v3
    v_and_b32 v1, 15, v0
    v_mov_b32 v3, 0x3f803f80
    v_cmp_eq_u32 vcc, v1, v2
    s_nop 1
    v_cndmask_b32 v20, 0, v3, vcc
    v_mov_b32 v21, v20
    v_mov_b32 v22, v20
    v_mov_b32 v23, v20
    s_lshl_b32 s33, s22, 8
    s_mul_i32 s23, s20, 200704
    s_add_u32 s33, s33, s23
    s_mul_i32 s30, s20, 7168
    s_lshr_b32 s23, s20, 1
    s_lshl_b32 s23, s23, 9
    s_and_b32 s24, s20, 1
    s_lshl_b32 s24, s24, 3
    s_add_u32 s23, s23, s24
    s_add_u32 s23, s23, 143360
    v_lshl_add_u32 v19, v0, 4, s23
    v_lshlrev_b32 v1, 4, v0
    s_setprio 2
    s_add_u32 s23, s2, s20
    s_cmp_lg_u32 s23, 0
    s_cbranch_scc1 K_NOEP
    s_memrealtime s[60:61]
    s_waitcnt lgkmcnt(0)
    s_or_b32 s60, s60, 1
    v_mov_b32 v2, 0
    v_mov_b32 v3, s60
    s_mov_b64 exec, 1
    global_store_dword v2, v3, s[54:55] sc0 sc1
    s_mov_b64 exec, -1
K_NOEP:
    s_waitcnt vmcnt(7)
    s_waitcnt lgkmcnt(0)
    s_barrier
    v_add_u32 v2, 0, v16
    ds_read_b64_tr_b16 v[40:41], v2 offset:0
    ds_read_b64_tr_b16 v[42:43], v2 offset:768
    ds_read_b64_tr_b16 v[44:45], v2 offset:64
    ds_read_b64_tr_b16 v[46:47], v2 offset:832
    ds_read_b64_tr_b16 v[48:49], v2 offset:128
    ds_read_b64_tr_b16 v[50:51], v2 offset:896
    s_add_u32 m0, s28, 69632
    s_add_u32 s23, s29, 256
    buffer_load_dwordx4 v12, s[4:7], s23 offen lds
    s_add_u32 m0, s28, 70656
    s_add_u32 s23, s29, 7424
    buffer_load_dwordx4 v13, s[4:7], s23 offen lds
    s_add_u32 m0, s28, 71680
    s_add_u32 s23, s29, 14592
    buffer_load_dwordx4 v12, s[4:7], s23 offen lds
    s_add_u32 m0, s28, 72704
    s_add_u32 s23, s29, 21760
    buffer_load_dwordx4 v13, s[4:7], s23 offen lds
    s_add_u32 m0, s25, 57344
    s_add_u32 s23, s32, 344064
    buffer_load_dwordx4 v8, s[8:11], s23 offen lds
    s_add_u32 m0, s25, 58368
    s_add_u32 s23, s32, 344064
    buffer_load_dwordx4 v9, s[8:11], s23 offen lds
    s_add_u32 m0, s25, 59392
    s_add_u32 s23, s32, 344064
    buffer_load_dwordx4 v10, s[8:11], s23 offen lds
    s_add_u32 m0, s28, 98304
    s_add_u32 s23, s29, 384
    buffer_load_dwordx4 v12, s[4:7], s23 offen lds
    s_add_u32 m0, s28, 99328
    s_add_u32 s23, s29, 7552
    buffer_load_dwordx4 v13, s[4:7], s23 offen lds
    s_waitcnt lgkmcnt(4)
    v_mfma_f32_16x16x32_bf16 v[24:27], v[20:23], v[40:43], 0
    s_waitcnt lgkmcnt(2)
    v_mfma_f32_16x16x32_bf16 v[28:31], v[20:23], v[44:47], 0
    s_waitcnt lgkmcnt(0)
    v_mfma_f32_16x16x32_bf16 v[32:35], v[20:23], v[48:51], 0
    s_waitcnt vmcnt(9)
    s_waitcnt lgkmcnt(0)
    s_barrier
    v_add_u32 v2, 28672, v16
    ds_read_b64_tr_b16 v[40:41], v2 offset:0
    ds_read_b64_tr_b16 v[42:43], v2 offset:768
    ds_read_b64_tr_b16 v[44:45], v2 offset:64
    ds_read_b64_tr_b16 v[46:47], v2 offset:832
    ds_read_b64_tr_b16 v[48:49], v2 offset:128
    ds_read_b64_tr_b16 v[50:51], v2 offset:896
    s_add_u32 m0, s28, 100352
    s_add_u32 s23, s29, 14720
    buffer_load_dwordx4 v12, s[4:7], s23 offen lds
    s_add_u32 m0, s28, 101376
    s_add_u32 s23, s29, 21888
    buffer_load_dwordx4 v13, s[4:7], s23 offen lds
    s_add_u32 m0, s25, 86016
    s_add_u32 s23, s32, 516096
    buffer_load_dwordx4 v8, s[8:11], s23 offen lds
    s_add_u32 m0, s25, 87040
    s_add_u32 s23, s32, 516096
    buffer_load_dwordx4 v9, s[8:11], s23 offen lds
    s_add_u32 m0, s25, 88064
    s_add_u32 s23, s32, 516096
    buffer_load_dwordx4 v10, s[8:11], s23 offen lds
    s_add_u32 m0, s28, 126976
    s_add_u32 s23, s29, 512
    buffer_load_dwordx4 v12, s[4:7], s23 offen lds
    s_add_u32 m0, s28, 128000
    s_add_u32 s23, s29, 7680
    buffer_load_dwordx4 v13, s[4:7], s23 offen lds
    s_add_u32 m0, s28, 129024
    s_add_u32 s23, s29, 14848
    buffer_load_dwordx4 v12, s[4:7], s23 offen lds
    s_add_u32 m0, s28, 130048
    s_add_u32 s23, s29, 22016
    buffer_load_dwordx4 v13, s[4:7], s23 offen lds
    s_waitcnt lgkmcnt(4)
    v_mfma_f32_16x16x32_bf16 v[24:27], v[20:23], v[40:43], v[24:27]
    s_waitcnt lgkmcnt(2)
    v_mfma_f32_16x16x32_bf16 v[28:31], v[20:23], v[44:47], v[28:31]
    s_waitcnt lgkmcnt(0)
    v_mfma_f32_16x16x32_bf16 v[32:35], v[20:23], v[48:51], v[32:35]
    s_waitcnt vmcnt(11)
    s_waitcnt lgkmcnt(0)
    s_barrier
    v_add_u32 v2, 57344, v16
    ds_read_b64_tr_b16 v[40:41], v2 offset:0
    ds_read_b64_tr_b16 v[42:43], v2 offset:768
    ds_read_b64_tr_b16 v[44:45], v2 offset:64
    ds_read_b64_tr_b16 v[46:47], v2 offset:832
    ds_read_b64_tr_b16 v[48:49], v2 offset:128
    ds_read_b64_tr_b16 v[50:51], v2 offset:896
    s_add_u32 m0, s25, 114688
    s_add_u32 s23, s32, 688128
    buffer_load_dwordx4 v8, s[8:11], s23 offen lds
    s_add_u32 m0, s25, 115712
    s_add_u32 s23, s32, 688128
    buffer_load_dwordx4 v9, s[8:11], s23 offen lds
    s_add_u32 m0, s25, 116736
    s_add_u32 s23, s32, 688128
    buffer_load_dwordx4 v10, s[8:11], s23 offen lds
    s_add_u32 m0, s28, 12288
    s_add_u32 s23, s29, 640
    buffer_load_dwordx4 v12, s[4:7], s23 offen lds
    s_add_u32 m0, s28, 13312
    s_add_u32 s23, s29, 7808
    buffer_load_dwordx4 v13, s[4:7], s23 offen lds
    s_add_u32 m0, s28, 14336
    s_add_u32 s23, s29, 14976
    buffer_load_dwordx4 v12, s[4:7], s23 offen lds
    s_add_u32 m0, s28, 15360
    s_add_u32 s23, s29, 22144
    buffer_load_dwordx4 v13, s[4:7], s23 offen lds
    s_add_u32 m0, s25, 0
    s_add_u32 s23, s32, 860160
    buffer_load_dwordx4 v8, s[8:11], s23 offen lds
    s_add_u32 m0, s25, 1024
    s_add_u32 s23, s32, 860160
    buffer_load_dwordx4 v9, s[8:11], s23 offen lds
    s_waitcnt lgkmcnt(4)
    v_mfma_f32_16x16x32_bf16 v[24:27], v[20:23], v[40:43], v[24:27]
    s_waitcnt lgkmcnt(2)
    v_mfma_f32_16x16x32_bf16 v[28:31], v[20:23], v[44:47], v[28:31]
    s_waitcnt lgkmcnt(0)
    v_mfma_f32_16x16x32_bf16 v[32:35], v[20:23], v[48:51], v[32:35]
    s_waitcnt vmcnt(13)
    s_waitcnt lgkmcnt(0)
    s_barrier
    v_add_u32 v2, 86016, v16
    ds_read_b64_tr_b16 v[40:41], v2 offset:0
    ds_read_b64_tr_b16 v[42:43], v2 offset:768
    ds_read_b64_tr_b16 v[44:45], v2 offset:64
    ds_read_b64_tr_b16 v[46:47], v2 offset:832
    ds_read_b64_tr_b16 v[48:49], v2 offset:128
    ds_read_b64_tr_b16 v[50:51], v2 offset:896
    s_add_u32 m0, s25, 2048
    s_add_u32 s23, s32, 860160
    buffer_load_dwordx4 v10, s[8:11], s23 offen lds
    s_add_u32 m0, s28, 40960
    s_add_u32 s23, s29, 768
    buffer_load_dwordx4 v12, s[4:7], s23 offen lds
    s_add_u32 m0, s28, 41984
    s_add_u32 s23, s29, 7936
    buffer_load_dwordx4 v13, s[4:7], s23 offen lds
    s_add_u32 m0, s28, 43008
    s_add_u32 s23, s29, 15104
    buffer_load_dwordx4 v12, s[4:7], s23 offen lds
    s_add_u32 m0, s28, 44032
    s_add_u32 s23, s29, 22272
    buffer_load_dwordx4 v13, s[4:7], s23 offen lds
    s_add_u32 m0, s25, 28672
    s_add_u32 s23, s32, 1032192
    buffer_load_dwordx4 v8, s[8:11], s23 offen lds
    s_add_u32 m0, s25, 29696
    s_add_u32 s23, s32, 1032192
    buffer_load_dwordx4 v9, s[8:11], s23 offen lds
    s_add_u32 m0, s25, 30720
    s_add_u32 s23, s32, 1032192
    buffer_load_dwordx4 v10, s[8:11], s23 offen lds
    s_waitcnt lgkmcnt(4)
    v_mfma_f32_16x16x32_bf16 v[24:27], v[20:23], v[40:43], v[24:27]
    s_waitcnt lgkmcnt(2)
    v_mfma_f32_16x16x32_bf16 v[28:31], v[20:23], v[44:47], v[28:31]
    s_waitcnt lgkmcnt(0)
    v_mfma_f32_16x16x32_bf16 v[32:35], v[20:23], v[48:51], v[32:35]
    s_waitcnt vmcnt(14)
    s_waitcnt lgkmcnt(0)
    s_barrier
    s_cmp_ge_u32 s22, 14
    s_cbranch_scc1 K_HTR
    v_add_u32 v2, 114688, v16
    ds_read_b64_tr_b16 v[40:41], v2 offset:0
    ds_read_b64_tr_b16 v[42:43], v2 offset:768
    ds_read_b64_tr_b16 v[44:45], v2 offset:64
    ds_read_b64_tr_b16 v[46:47], v2 offset:832
    ds_read_b64_tr_b16 v[48:49], v2 offset:128
    ds_read_b64_tr_b16 v[50:51], v2 offset:896
    s_add_u32 m0, s30, 57344
    s_add_u32 s23, s33, 0
    buffer_load_dwordx4 v14, s[12:15], s23 offen lds
    s_add_u32 m0, s30, 58368
    s_add_u32 s23, s33, 28672
    buffer_load_dwordx4 v14, s[12:15], s23 offen lds
    s_add_u32 m0, s30, 59392
    s_add_u32 s23, s33, 57344
    buffer_load_dwordx4 v14, s[12:15], s23 offen lds
    s_add_u32 m0, s30, 60416
    s_add_u32 s23, s33, 86016
    buffer_load_dwordx4 v14, s[12:15], s23 offen lds
    s_add_u32 m0, s30, 61440
    s_add_u32 s23, s33, 114688
    buffer_load_dwordx4 v14, s[12:15], s23 offen lds
    s_add_u32 m0, s30, 62464
    s_add_u32 s23, s33, 143360
    buffer_load_dwordx4 v14, s[12:15], s23 offen lds
    s_add_u32 m0, s30, 63488
    s_add_u32 s23, s33, 172032
    buffer_load_dwordx4 v14, s[12:15], s23 offen lds
    s_add_u32 m0, s30, 86016
    s_add_u32 s23, s33, 802816
    buffer_load_dwordx4 v14, s[12:15], s23 offen lds
    s_add_u32 m0, s30, 87040
    s_add_u32 s23, s33, 831488
    buffer_load_dwordx4 v14, s[12:15], s23 offen lds
    s_add_u32 m0, s30, 88064
    s_add_u32 s23, s33, 860160
    buffer_load_dwordx4 v14, s[12:15], s23 offen lds
    s_waitcnt lgkmcnt(4)
    v_mfma_f32_16x16x32_bf16 v[24:27], v[20:23], v[40:43], v[24:27]
    s_waitcnt lgkmcnt(2)
    v_mfma_f32_16x16x32_bf16 v[28:31], v[20:23], v[44:47], v[28:31]
    s_waitcnt lgkmcnt(0)
    v_mfma_f32_16x16x32_bf16 v[32:35], v[20:23], v[48:51], v[32:35]
    s_waitcnt vmcnt(17)
    s_waitcnt lgkmcnt(0)
    s_barrier
    v_add_u32 v2, 0, v16
    ds_read_b64_tr_b16 v[40:41], v2 offset:0
    ds_read_b64_tr_b16 v[42:43], v2 offset:768
    ds_read_b64_tr_b16 v[44:45], v2 offset:64
    ds_read_b64_tr_b16 v[46:47], v2 offset:832
    ds_read_b64_tr_b16 v[48:49], v2 offset:128
    ds_read_b64_tr_b16 v[50:51], v2 offset:896
    s_add_u32 m0, s30, 89088
    s_add_u32 s23, s33, 888832
    buffer_load_dwordx4 v14, s[12:15], s23 offen lds
    s_add_u32 m0, s30, 90112
    s_add_u32 s23, s33, 917504
    buffer_load_dwordx4 v14, s[12:15], s23 offen lds
    s_add_u32 m0, s30, 91136
    s_add_u32 s23, s33, 946176
    buffer_load_dwordx4 v14, s[12:15], s23 offen lds
    s_add_u32 m0, s30, 92160
    s_add_u32 s23, s33, 974848
    buffer_load_dwordx4 v14, s[12:15], s23 offen lds
    s_add_u32 m0, s30, 114688
    s_add_u32 s23, s33, 128
    buffer_load_dwordx4 v14, s[12:15], s23 offen lds
    s_add_u32 m0, s30, 115712
    s_add_u32 s23, s33, 28800
    buffer_load_dwordx4 v14, s[12:15], s23 offen lds
    s_add_u32 m0, s30, 116736
    s_add_u32 s23, s33, 57472
    buffer_load_dwordx4 v14, s[12:15], s23 offen lds
    s_add_u32 m0, s30, 117760
    s_add_u32 s23, s33, 86144
    buffer_load_dwordx4 v14, s[12:15], s23 offen lds
    s_add_u32 m0, s30, 118784
    s_add_u32 s23, s33, 114816
    buffer_load_dwordx4 v14, s[12:15], s23 offen lds
    s_add_u32 m0, s30, 119808
    s_add_u32 s23, s33, 143488
    buffer_load_dwordx4 v14, s[12:15], s23 offen lds
    s_waitcnt lgkmcnt(4)
    v_mfma_f32_16x16x32_bf16 v[24:27], v[20:23], v[40:43], v[24:27]
    s_waitcnt lgkmcnt(2)
    v_mfma_f32_16x16x32_bf16 v[28:31], v[20:23], v[44:47], v[28:31]
    s_waitcnt lgkmcnt(0)
    v_mfma_f32_16x16x32_bf16 v[32:35], v[20:23], v[48:51], v[32:35]
    s_waitcnt vmcnt(20)
    s_waitcnt lgkmcnt(0)
    s_barrier
    v_add_u32 v2, 28672, v16
    ds_read_b64_tr_b16 v[40:41], v2 offset:0
    ds_read_b64_tr_b16 v[42:43], v2 offset:768
    ds_read_b64_tr_b16 v[44:45], v2 offset:64
    ds_read_b64_tr_b16 v[46:47], v2 offset:832
    ds_read_b64_tr_b16 v[48:49], v2 offset:128
    ds_read_b64_tr_b16 v[50:51], v2 offset:896
    s_add_u32 m0, s30, 120832
    s_add_u32 s23, s33, 172160
    buffer_load_dwordx4 v14, s[12:15], s23 offen lds
    s_add_u32 m0, s30, 0
    s_add_u32 s23, s33, 802944
    buffer_load_dwordx4 v14, s[12:15], s23 offen lds
    s_add_u32 m0, s30, 1024
    s_add_u32 s23, s33, 831616
    buffer_load_dwordx4 v14, s[12:15], s23 offen lds
    s_add_u32 m0, s30, 2048
    s_add_u32 s23, s33, 860288
    buffer_load_dwordx4 v14, s[12:15], s23 offen lds
    s_add_u32 m0, s30, 3072
    s_add_u32 s23, s33, 888960
    buffer_load_dwordx4 v14, s[12:15], s23 offen lds
    s_add_u32 m0, s30, 4096
    s_add_u32 s23, s33, 917632
    buffer_load_dwordx4 v14, s[12:15], s23 offen lds
    s_add_u32 m0, s30, 5120
    s_add_u32 s23, s33, 946304
    buffer_load_dwordx4 v14, s[12:15], s23 offen lds
    s_add_u32 m0, s30, 6144
    s_add_u32 s23, s33, 974976
    buffer_load_dwordx4 v14, s[12:15], s23 offen lds
    s_waitcnt lgkmcnt(4)
    v_mfma_f32_16x16x32_bf16 v[24:27], v[20:23], v[40:43], v[24:27]
    s_waitcnt lgkmcnt(2)
    v_mfma_f32_16x16x32_bf16 v[28:31], v[20:23], v[44:47], v[28:31]
    s_waitcnt lgkmcnt(0)
    v_mfma_f32_16x16x32_bf16 v[32:35], v[20:23], v[48:51], v[32:35]
    s_nop 3
    v_and_b32 v40, 0xffff0000, v24
    v_sub_f32 v41, v24, v40
    v_and_b32 v42, 0xffff0000, v41
    v_sub_f32 v41, v41, v42
    v_lshrrev_b32 v40, 16, v40
    v_or_b32 v40, v40, v42
    v_lshrrev_b32 v41, 16, v41
    v_and_b32 v44, 0xffff0000, v25
    v_sub_f32 v45, v25, v44
    v_and_b32 v46, 0xffff0000, v45
    v_sub_f32 v45, v45, v46
    v_lshrrev_b32 v44, 16, v44
    v_or_b32 v44, v44, v46
    v_lshrrev_b32 v45, 16, v45
    v_and_b32 v48, 0xffff0000, v28
    v_sub_f32 v49, v28, v48
    v_and_b32 v50, 0xffff0000, v49
    v_sub_f32 v49, v49, v50
    v_lshrrev_b32 v48, 16, v48
    v_or_b32 v48, v48, v50
    v_lshrrev_b32 v49, 16, v49
    v_and_b32 v52, 0xffff0000, v29
    v_sub_f32 v53, v29, v52
    v_and_b32 v54, 0xffff0000, v53
    v_sub_f32 v53, v53, v54
    v_lshrrev_b32 v52, 16, v52
    v_or_b32 v52, v52, v54
    v_lshrrev_b32 v53, 16, v53
    v_and_b32 v56, 0xffff0000, v32
    v_sub_f32 v57, v32, v56
    v_and_b32 v58, 0xffff0000, v57
    v_sub_f32 v57, v57, v58
    v_lshrrev_b32 v56, 16, v56
    v_or_b32 v56, v56, v58
    v_lshrrev_b32 v57, 16, v57
    v_and_b32 v60, 0xffff0000, v33
    v_sub_f32 v61, v33, v60
    v_and_b32 v62, 0xffff0000, v61
    v_sub_f32 v61, v61, v62
    v_lshrrev_b32 v60, 16, v60
    v_or_b32 v60, v60, v62
    v_lshrrev_b32 v61, 16, v61
    s_mov_b64 exec, 0xffff
    ds_write_b64 v19, v[40:41] offset:0
    ds_write_b64 v19, v[44:45] offset:256
    ds_write_b64 v19, v[48:49] offset:1024
    ds_write_b64 v19, v[52:53] offset:1280
    ds_write_b64 v19, v[56:57] offset:2048
    ds_write_b64 v19, v[60:61] offset:2304
    s_mov_b64 exec, -1
    s_waitcnt vmcnt(14)
    s_waitcnt lgkmcnt(0)
    s_barrier
    s_lshl_b32 s23, s20, 11
    s_add_u32 s23, s23, 28672
    v_add_u32 v124, s23, v1
    v_bfe_u32 v2, v0, 4, 1
    v_lshl_add_u32 v125, v2, 10, s23
    v_lshrrev_b32 v2, 5, v0
    v_lshl_add_u32 v125, v2, 6, v125
    v_bfe_u32 v2, v0, 2, 2
    v_lshl_add_u32 v125, v2, 4, v125
    v_and_b32 v2, 1, v0
    v_lshl_add_u32 v125, v2, 9, v125
    v_bfe_u32 v2, v0, 1, 1
    v_lshl_add_u32 v125, v2, 3, v125
    v_and_b32 v2, 31, v0
    v_cmp_gt_u32 vcc, 28, v2
    s_nop 1
    v_cndmask_b32 v126, 0, -1, vcc
    v_mov_b32 v3, 0x3f803f80
    v_cmp_eq_u32 vcc, 28, v2
    s_nop 1
    v_cndmask_b32 v127, 0, v3, vcc
    s_add_u32 s35, s21, s20
    s_waitcnt vmcnt(0)
    s_waitcnt lgkmcnt(0)
    s_barrier
    v_mov_b32 v2, 154624
    ds_read_b32 v15, v2
    s_mul_i32 s27, s22, 3
    s_cmp_ge_u32 s27, 32
    s_cbranch_scc1 K_RV0
    ds_read_b128 v[100:103], v124 offset:0
    ds_read_b128 v[104:107], v124 offset:1024
    s_branch K_RW0
K_RV0:
    ds_read_b64_tr_b16 v[100:101], v125 offset:0
    ds_read_b64_tr_b16 v[102:103], v125 offset:128
    ds_read_b64_tr_b16 v[104:105], v125 offset:256
    ds_read_b64_tr_b16 v[106:107], v125 offset:384
K_RW0:
    s_cmp_ge_u32 s27, 31
    s_cbranch_scc1 K_RV1
    ds_read_b128 v[108:111], v124 offset:8192
    ds_read_b128 v[112:115], v124 offset:9216
    s_branch K_RW1
K_RV1:
    ds_read_b64_tr_b16 v[108:109], v125 offset:8192
    ds_read_b64_tr_b16 v[110:111], v125 offset:8320
    ds_read_b64_tr_b16 v[112:113], v125 offset:8448
    ds_read_b64_tr_b16 v[114:115], v125 offset:8576
K_RW1:
    s_cmp_ge_u32 s27, 30
    s_cbranch_scc1 K_RV2
    ds_read_b128 v[116:119], v124 offset:16384
    ds_read_b128 v[120:123], v124 offset:17408
    s_branch K_RW2
K_RV2:
    ds_read_b64_tr_b16 v[116:117], v125 offset:16384
    ds_read_b64_tr_b16 v[118:119], v125 offset:16512
    ds_read_b64_tr_b16 v[120:121], v125 offset:16640
    ds_read_b64_tr_b16 v[122:123], v125 offset:16768
K_RW2:
    s_waitcnt lgkmcnt(0)
    s_add_u32 s23, s27, 0
    s_lshr_b32 s24, s23, 4
    s_and_b32 s23, s23, 15
    s_lshl_b32 s23, s23, 6
    s_add_u32 s23, s23, s35
    s_lshl_b32 s26, s23, 11
    s_lshl_b32 s23, s23, 12
    s_add_u32 s23, s23, 2097152
    s_cmp_eq_u32 s24, 0
    s_cselect_b32 s26, s26, s23
    s_cselect_b32 s23, 0, 0x3f803f80
    s_cselect_b32 s34, 0, 0x3f80
    s_cmp_eq_u32 s24, 2
    s_cbranch_scc1 K_FV0
    s_mov_b32 exec_lo, 0
    v_mov_b32 v106, s23
    v_mov_b32 v107, s34
    s_mov_b32 exec_lo, -1
    s_branch K_FW0
K_FV0:
    v_and_or_b32 v100, v100, v126, v127
    v_and_or_b32 v101, v101, v126, v127
    v_and_or_b32 v102, v102, v126, v127
    v_and_or_b32 v103, v103, v126, v127
    v_and_or_b32 v104, v104, v126, v127
    v_and_or_b32 v105, v105, v126, v127
    v_and_or_b32 v106, v106, v126, v127
    v_and_or_b32 v107, v107, v126, v127
    s_add_u32 s26, s26, 2048
K_FW0:
    buffer_store_dwordx4 v[100:103], v1, s[16:19], s26 offen sc1
    buffer_store_dwordx4 v[104:107], v1, s[16:19], s26 offen offset:1024 sc1
    s_add_u32 s23, s27, 1
    s_lshr_b32 s24, s23, 4
    s_and_b32 s23, s23, 15
    s_lshl_b32 s23, s23, 6
    s_add_u32 s23, s23, s35
    s_lshl_b32 s26, s23, 11
    s_lshl_b32 s23, s23, 12
    s_add_u32 s23, s23, 2097152
    s_cmp_eq_u32 s24, 0
    s_cselect_b32 s26, s26, s23
    s_cselect_b32 s23, 0, 0x3f803f80
    s_cselect_b32 s34, 0, 0x3f80
    s_cmp_eq_u32 s24, 2
    s_cbranch_scc1 K_FV1
    s_mov_b32 exec_lo, 0
    v_mov_b32 v114, s23
    v_mov_b32 v115, s34
    s_mov_b32 exec_lo, -1
    s_branch K_FW1
K_FV1:
    v_and_or_b32 v108, v108, v126, v127
    v_and_or_b32 v109, v109, v126, v127
    v_and_or_b32 v110, v110, v126, v127
    v_and_or_b32 v111, v111, v126, v127
    v_and_or_b32 v112, v112, v126, v127
    v_and_or_b32 v113, v113, v126, v127
    v_and_or_b32 v114, v114, v126, v127
    v_and_or_b32 v115, v115, v126, v127
    s_add_u32 s26, s26, 2048
K_FW1:
    buffer_store_dwordx4 v[108:111], v1, s[16:19], s26 offen sc1
    buffer_store_dwordx4 v[112:115], v1, s[16:19], s26 offen offset:1024 sc1
    s_add_u32 s23, s27, 2
    s_lshr_b32 s24, s23, 4
    s_and_b32 s23, s23, 15
    s_lshl_b32 s23, s23, 6
    s_add_u32 s23, s23, s35
    s_lshl_b32 s26, s23, 11
    s_lshl_b32 s23, s23, 12
    s_add_u32 s23, s23, 2097152
    s_cmp_eq_u32 s24, 0
    s_cselect_b32 s26, s26, s23
    s_cselect_b32 s23, 0, 0x3f803f80
    s_cselect_b32 s34, 0, 0x3f80
    s_cmp_eq_u32 s24, 2
    s_cbranch_scc1 K_FV2
    s_mov_b32 exec_lo, 0
    v_mov_b32 v122, s23
    v_mov_b32 v123, s34
    s_mov_b32 exec_lo, -1
    s_branch K_FW2
K_FV2:
    v_and_or_b32 v116, v116, v126, v127
    v_and_or_b32 v117, v117, v126, v127
    v_and_or_b32 v118, v118, v126, v127
    v_and_or_b32 v119, v119, v126, v127
    v_and_or_b32 v120, v120, v126, v127
    v_and_or_b32 v121, v121, v126, v127
    v_and_or_b32 v122, v122, v126, v127
    v_and_or_b32 v123, v123, v126, v127
    s_add_u32 s26, s26, 2048
K_FW2:
    buffer_store_dwordx4 v[116:119], v1, s[16:19], s26 offen sc1
    buffer_store_dwordx4 v[120:123], v1, s[16:19], s26 offen offset:1024 sc1
    s_mul_i32 s23, s20, 14336
    s_cmp_lt_u32 s20, 2
    s_mov_b32 s24, 57344
    s_cselect_b32 s24, 57344, s24
    s_add_u32 s23, s23, s24
    v_add_u32 v2, s23, v17
    v_add_u32 v3, s23, v18
    ds_read_b64_tr_b16 v[40:41], v2 offset:0
    ds_read_b64_tr_b16 v[42:43], v2 offset:512
    ds_read_b64_tr_b16 v[44:45], v3 offset:0
    ds_read_b64_tr_b16 v[46:47], v3 offset:512
    ds_read_b64_tr_b16 v[48:49], v2 offset:2048
    ds_read_b64_tr_b16 v[50:51], v2 offset:2560
    ds_read_b64_tr_b16 v[52:53], v3 offset:2048
    ds_read_b64_tr_b16 v[54:55], v3 offset:2560
    ds_read_b64_tr_b16 v[56:57], v2 offset:4096
    ds_read_b64_tr_b16 v[58:59], v2 offset:4608
    ds_read_b64_tr_b16 v[60:61], v3 offset:4096
    ds_read_b64_tr_b16 v[62:63], v3 offset:4608
    ds_read_b64_tr_b16 v[64:65], v2 offset:6144
    ds_read_b64_tr_b16 v[66:67], v2 offset:6656
    s_waitcnt lgkmcnt(12)
    v_mfma_f32_16x16x32_bf16 v[24:27], v[20:23], v[40:43], 0
    ds_read_b64_tr_b16 v[68:69], v3 offset:6144
    ds_read_b64_tr_b16 v[70:71], v3 offset:6656
    s_waitcnt lgkmcnt(12)
    v_mfma_f32_16x16x32_bf16 v[28:31], v[20:23], v[44:47], 0
    ds_read_b64_tr_b16 v[72:73], v2 offset:8192
    ds_read_b64_tr_b16 v[74:75], v2 offset:8704
    s_waitcnt lgkmcnt(12)
    v_mfma_f32_16x16x32_bf16 v[24:27], v[20:23], v[48:51], v[24:27]
    ds_read_b64_tr_b16 v[76:77], v3 offset:8192
    ds_read_b64_tr_b16 v[78:79], v3 offset:8704
    s_waitcnt lgkmcnt(12)
    v_mfma_f32_16x16x32_bf16 v[28:31], v[20:23], v[52:55], v[28:31]
    ds_read_b64_tr_b16 v[80:81], v2 offset:10240
    ds_read_b64_tr_b16 v[82:83], v2 offset:10752
    s_waitcnt lgkmcnt(12)
    v_mfma_f32_16x16x32_bf16 v[24:27], v[20:23], v[56:59], v[24:27]
    ds_read_b64_tr_b16 v[84:85], v3 offset:10240
    ds_read_b64_tr_b16 v[86:87], v3 offset:10752
    s_waitcnt lgkmcnt(12)
    v_mfma_f32_16x16x32_bf16 v[28:31], v[20:23], v[60:63], v[28:31]
    ds_read_b64_tr_b16 v[88:89], v2 offset:12288
    ds_read_b64_tr_b16 v[90:91], v2 offset:12800
    s_waitcnt lgkmcnt(12)
    v_mfma_f32_16x16x32_bf16 v[24:27], v[20:23], v[64:67], v[24:27]
    ds_read_b64_tr_b16 v[92:93], v3 offset:12288
    ds_read_b64_tr_b16 v[94:95], v3 offset:12800
    s_waitcnt lgkmcnt(12)
    v_mfma_f32_16x16x32_bf16 v[28:31], v[20:23], v[68:71], v[28:31]
    s_waitcnt lgkmcnt(10)
    v_mfma_f32_16x16x32_bf16 v[24:27], v[20:23], v[72:75], v[24:27]
    s_waitcnt lgkmcnt(8)
    v_mfma_f32_16x16x32_bf16 v[28:31], v[20:23], v[76:79], v[28:31]
    s_waitcnt lgkmcnt(6)
    v_mfma_f32_16x16x32_bf16 v[24:27], v[20:23], v[80:83], v[24:27]
    s_waitcnt lgkmcnt(4)
    v_mfma_f32_16x16x32_bf16 v[28:31], v[20:23], v[84:87], v[28:31]
    s_waitcnt lgkmcnt(2)
    v_mfma_f32_16x16x32_bf16 v[24:27], v[20:23], v[88:91], v[24:27]
    s_waitcnt lgkmcnt(0)
    v_mfma_f32_16x16x32_bf16 v[28:31], v[20:23], v[92:95], v[28:31]
    s_nop 5
    v_and_b32 v40, 0xffff0000, v24
    v_sub_f32 v41, v24, v40
    v_and_b32 v42, 0xffff0000, v41
    v_sub_f32 v41, v41, v42
    v_lshrrev_b32 v40, 16, v40
    v_or_b32 v40, v40, v42
    v_lshrrev_b32 v41, 16, v41
    v_and_b32 v44, 0xffff0000, v25
    v_sub_f32 v45, v25, v44
    v_and_b32 v46, 0xffff0000, v45
    v_sub_f32 v45, v45, v46
    v_lshrrev_b32 v44, 16, v44
    v_or_b32 v44, v44, v46
    v_lshrrev_b32 v45, 16, v45
    v_and_b32 v48, 0xffff0000, v28
    v_sub_f32 v49, v28, v48
    v_and_b32 v50, 0xffff0000, v49
    v_sub_f32 v49, v49, v50
    v_lshrrev_b32 v48, 16, v48
    v_or_b32 v48, v48, v50
    v_lshrrev_b32 v49, 16, v49
    v_and_b32 v52, 0xffff0000, v29
    v_sub_f32 v53, v29, v52
    v_and_b32 v54, 0xffff0000, v53
    v_sub_f32 v53, v53, v54
    v_lshrrev_b32 v52, 16, v52
    v_or_b32 v52, v52, v54
    v_lshrrev_b32 v53, 16, v53
    s_mov_b64 exec, 0xffff
    ds_write_b64 v19, v[40:41] offset:3072
    ds_write_b64 v19, v[44:45] offset:3328
    ds_write_b64 v19, v[48:49] offset:4096
    ds_write_b64 v19, v[52:53] offset:4352
    s_mov_b64 exec, -1
    s_lshl_b32 s23, s22, 6
    s_add_u32 s23, s23, s35
    s_lshl_b32 s23, s23, 2
    s_add_u32 s23, s23, 18874368
    s_mov_b64 exec, 1
    s_waitcnt vmcnt(0)
    buffer_store_dword v15, v1, s[16:19], s23 offen sc1
    s_mov_b64 exec, -1
    s_waitcnt lgkmcnt(0)
    s_barrier
    s_mul_i32 s23, s20, 14336
    s_cmp_lt_u32 s20, 2
    s_mov_b32 s24, 4294938624
    s_cselect_b32 s24, 114688, s24
    s_add_u32 s23, s23, s24
    v_add_u32 v2, s23, v17
    v_add_u32 v3, s23, v18
    ds_read_b64_tr_b16 v[40:41], v2 offset:0
    ds_read_b64_tr_b16 v[42:43], v2 offset:512
    ds_read_b64_tr_b16 v[44:45], v3 offset:0
    ds_read_b64_tr_b16 v[46:47], v3 offset:512
    ds_read_b64_tr_b16 v[48:49], v2 offset:2048
    ds_read_b64_tr_b16 v[50:51], v2 offset:2560
    ds_read_b64_tr_b16 v[52:53], v3 offset:2048
    ds_read_b64_tr_b16 v[54:55], v3 offset:2560
    ds_read_b64_tr_b16 v[56:57], v2 offset:4096
    ds_read_b64_tr_b16 v[58:59], v2 offset:4608
    ds_read_b64_tr_b16 v[60:61], v3 offset:4096
    ds_read_b64_tr_b16 v[62:63], v3 offset:4608
    ds_read_b64_tr_b16 v[64:65], v2 offset:6144
    ds_read_b64_tr_b16 v[66:67], v2 offset:6656
    s_waitcnt lgkmcnt(12)
    v_mfma_f32_16x16x32_bf16 v[24:27], v[20:23], v[40:43], 0
    ds_read_b64_tr_b16 v[68:69], v3 offset:6144
    ds_read_b64_tr_b16 v[70:71], v3 offset:6656
    s_waitcnt lgkmcnt(12)
    v_mfma_f32_16x16x32_bf16 v[28:31], v[20:23], v[44:47], 0
    ds_read_b64_tr_b16 v[72:73], v2 offset:8192
    ds_read_b64_tr_b16 v[74:75], v2 offset:8704
    s_waitcnt lgkmcnt(12)
    v_mfma_f32_16x16x32_bf16 v[24:27], v[20:23], v[48:51], v[24:27]
    ds_read_b64_tr_b16 v[76:77], v3 offset:8192
    ds_read_b64_tr_b16 v[78:79], v3 offset:8704
    s_waitcnt lgkmcnt(12)
    v_mfma_f32_16x16x32_bf16 v[28:31], v[20:23], v[52:55], v[28:31]
    ds_read_b64_tr_b16 v[80:81], v2 offset:10240
    ds_read_b64_tr_b16 v[82:83], v2 offset:10752
    s_waitcnt lgkmcnt(12)
    v_mfma_f32_16x16x32_bf16 v[24:27], v[20:23], v[56:59], v[24:27]
    ds_read_b64_tr_b16 v[84:85], v3 offset:10240
    ds_read_b64_tr_b16 v[86:87], v3 offset:10752
    s_waitcnt lgkmcnt(12)
    v_mfma_f32_16x16x32_bf16 v[28:31], v[20:23], v[60:63], v[28:31]
    ds_read_b64_tr_b16 v[88:89], v2 offset:12288
    ds_read_b64_tr_b16 v[90:91], v2 offset:12800
    s_waitcnt lgkmcnt(12)
    v_mfma_f32_16x16x32_bf16 v[24:27], v[20:23], v[64:67], v[24:27]
    ds_read_b64_tr_b16 v[92:93], v3 offset:12288
    ds_read_b64_tr_b16 v[94:95], v3 offset:12800
    s_waitcnt lgkmcnt(12)
    v_mfma_f32_16x16x32_bf16 v[28:31], v[20:23], v[68:71], v[28:31]
    s_waitcnt lgkmcnt(10)
    v_mfma_f32_16x16x32_bf16 v[24:27], v[20:23], v[72:75], v[24:27]
    s_waitcnt lgkmcnt(8)
    v_mfma_f32_16x16x32_bf16 v[28:31], v[20:23], v[76:79], v[28:31]
    s_waitcnt lgkmcnt(6)
    v_mfma_f32_16x16x32_bf16 v[24:27], v[20:23], v[80:83], v[24:27]
    s_waitcnt lgkmcnt(4)
    v_mfma_f32_16x16x32_bf16 v[28:31], v[20:23], v[84:87], v[28:31]
    s_waitcnt lgkmcnt(2)
    v_mfma_f32_16x16x32_bf16 v[24:27], v[20:23], v[88:91], v[24:27]
    s_waitcnt lgkmcnt(0)
    v_mfma_f32_16x16x32_bf16 v[28:31], v[20:23], v[92:95], v[28:31]
    s_nop 5
    v_and_b32 v40, 0xffff0000, v24
    v_sub_f32 v41, v24, v40
    v_and_b32 v42, 0xffff0000, v41
    v_sub_f32 v41, v41, v42
    v_lshrrev_b32 v40, 16, v40
    v_or_b32 v40, v40, v42
    v_lshrrev_b32 v41, 16, v41
    v_and_b32 v44, 0xffff0000, v25
    v_sub_f32 v45, v25, v44
    v_and_b32 v46, 0xffff0000, v45
    v_sub_f32 v45, v45, v46
    v_lshrrev_b32 v44, 16, v44
    v_or_b32 v44, v44, v46
    v_lshrrev_b32 v45, 16, v45
    v_and_b32 v48, 0xffff0000, v28
    v_sub_f32 v49, v28, v48
    v_and_b32 v50, 0xffff0000, v49
    v_sub_f32 v49, v49, v50
    v_lshrrev_b32 v48, 16, v48
    v_or_b32 v48, v48, v50
    v_lshrrev_b32 v49, 16, v49
    v_and_b32 v52, 0xffff0000, v29
    v_sub_f32 v53, v29, v52
    v_and_b32 v54, 0xffff0000, v53
    v_sub_f32 v53, v53, v54
    v_lshrrev_b32 v52, 16, v52
    v_or_b32 v52, v52, v54
    v_lshrrev_b32 v53, 16, v53
    s_mov_b64 exec, 0xffff
    ds_write_b64 v19, v[40:41] offset:5120
    ds_write_b64 v19, v[44:45] offset:5376
    ds_write_b64 v19, v[48:49] offset:6144
    ds_write_b64 v19, v[52:53] offset:6400
    s_mov_b64 exec, -1
    s_waitcnt lgkmcnt(0)
    s_barrier
    v_add_u32 v2, 28672, v124
    ds_read_b128 v[100:103], v2 offset:0
    ds_read_b128 v[104:107], v2 offset:1024
    ds_read_b128 v[108:111], v2 offset:8192
    ds_read_b128 v[112:115], v2 offset:9216
    s_mul_i32 s26, s35, 114688
    s_lshl_b32 s23, s22, 13
    s_add_u32 s26, s26, s23
    s_add_u32 s26, s26, 6291456
    s_waitcnt lgkmcnt(3)
    v_pk_max_i16 v100, v100, 0
    v_pk_max_i16 v101, v101, 0
    v_pk_max_i16 v102, v102, 0
    v_pk_max_i16 v103, v103, 0
    buffer_store_dwordx4 v[100:103], v1, s[16:19], s26 offen offset:0 sc1
    s_waitcnt lgkmcnt(2)
    v_pk_max_i16 v104, v104, 0
    v_pk_max_i16 v105, v105, 0
    v_pk_max_i16 v106, v106, 0
    v_pk_max_i16 v107, v107, 0
    buffer_store_dwordx4 v[104:107], v1, s[16:19], s26 offen offset:1024 sc1
    s_waitcnt lgkmcnt(1)
    v_pk_max_i16 v108, v108, 0
    v_pk_max_i16 v109, v109, 0
    v_pk_max_i16 v110, v110, 0
    v_pk_max_i16 v111, v111, 0
    buffer_store_dwordx4 v[108:111], v1, s[16:19], s26 offen offset:2048 sc1
    s_waitcnt lgkmcnt(0)
    v_pk_max_i16 v112, v112, 0
    v_pk_max_i16 v113, v113, 0
    v_pk_max_i16 v114, v114, 0
    v_pk_max_i16 v115, v115, 0
    buffer_store_dwordx4 v[112:115], v1, s[16:19], s26 offen offset:3072 sc1
    s_waitcnt lgkmcnt(0)
    s_barrier
    v_add_u32 v2, 57344, v124
    ds_read_b128 v[100:103], v2 offset:0
    ds_read_b128 v[104:107], v2 offset:1024
    ds_read_b128 v[108:111], v2 offset:8192
    ds_read_b128 v[112:115], v2 offset:9216
    s_mul_i32 s26, s35, 114688
    s_lshl_b32 s23, s22, 13
    s_add_u32 s26, s26, s23
    s_add_u32 s26, s26, 6295552
    s_waitcnt lgkmcnt(3)
    v_pk_max_i16 v100, v100, 0
    v_pk_max_i16 v101, v101, 0
    v_pk_max_i16 v102, v102, 0
    v_pk_max_i16 v103, v103, 0
    buffer_store_dwordx4 v[100:103], v1, s[16:19], s26 offen offset:0 sc1
    s_waitcnt lgkmcnt(2)
    v_pk_max_i16 v104, v104, 0
    v_pk_max_i16 v105, v105, 0
    v_pk_max_i16 v106, v106, 0
    v_pk_max_i16 v107, v107, 0
    buffer_store_dwordx4 v[104:107], v1, s[16:19], s26 offen offset:1024 sc1
    s_waitcnt lgkmcnt(1)
    v_pk_max_i16 v108, v108, 0
    v_pk_max_i16 v109, v109, 0
    v_pk_max_i16 v110, v110, 0
    v_pk_max_i16 v111, v111, 0
    buffer_store_dwordx4 v[108:111], v1, s[16:19], s26 offen offset:2048 sc1
    s_waitcnt lgkmcnt(0)
    v_pk_max_i16 v112, v112, 0
    v_pk_max_i16 v113, v113, 0
    v_pk_max_i16 v114, v114, 0
    v_pk_max_i16 v115, v115, 0
    buffer_store_dwordx4 v[112:115], v1, s[16:19], s26 offen offset:3072 sc1
    s_lshl_b32 s23, s35, 4
    s_add_u32 s23, s23, s22
    s_lshl_b32 s23, s23, 2
    s_add_u32 s23, s23, 18878464
    s_mov_b64 exec, 1
    s_waitcnt vmcnt(0)
    buffer_store_dword v15, v1, s[16:19], s23 offen sc1
    s_mov_b64 exec, -1
    s_branch K_GEMM
K_HTR:
    s_mov_b32 s8, s50
    s_and_b32 s9, s51, 0xffff
    s_mov_b32 s10, 1605632
    s_mov_b32 s11, 0x00020000
    s_sub_u32 s32, s22, 14
    s_lshl_b32 s32, s32, 6
    s_add_u32 s32, s32, s21
    s_add_u32 s32, s32, s20
    s_mul_i32 s30, s20, 14336
    s_add_u32 s30, s30, 57344
    s_mul_i32 s25, s32, 14336
    s_add_u32 m0, s30, 0
    s_add_u32 s23, s25, 0
    buffer_load_dwordx4 v1, s[8:11], s23 offen offset:0 lds
    buffer_load_dwordx4 v1, s[8:11], s23 offen offset:1024 lds
    buffer_load_dwordx4 v1, s[8:11], s23 offen offset:2048 lds
    buffer_load_dwordx4 v1, s[8:11], s23 offen offset:3072 lds
    s_add_u32 m0, s30, 4096
    s_add_u32 s23, s25, 4096
    buffer_load_dwordx4 v1, s[8:11], s23 offen offset:0 lds
    buffer_load_dwordx4 v1, s[8:11], s23 offen offset:1024 lds
    buffer_load_dwordx4 v1, s[8:11], s23 offen offset:2048 lds
    buffer_load_dwordx4 v1, s[8:11], s23 offen offset:3072 lds
    s_add_u32 m0, s30, 8192
    s_add_u32 s23, s25, 8192
    buffer_load_dwordx4 v1, s[8:11], s23 offen offset:0 lds
    buffer_load_dwordx4 v1, s[8:11], s23 offen offset:1024 lds
    buffer_load_dwordx4 v1, s[8:11], s23 offen offset:2048 lds
    buffer_load_dwordx4 v1, s[8:11], s23 offen offset:3072 lds
    s_add_u32 m0, s30, 12288
    s_add_u32 s23, s25, 12288
    buffer_load_dwordx4 v1, s[8:11], s23 offen offset:0 lds
    buffer_load_dwordx4 v1, s[8:11], s23 offen offset:1024 lds
    v_add_u32 v2, 114688, v16
    ds_read_b64_tr_b16 v[40:41], v2 offset:0
    ds_read_b64_tr_b16 v[42:43], v2 offset:768
    ds_read_b64_tr_b16 v[44:45], v2 offset:64
    ds_read_b64_tr_b16 v[46:47], v2 offset:832
    ds_read_b64_tr_b16 v[48:49], v2 offset:128
    ds_read_b64_tr_b16 v[50:51], v2 offset:896
    s_waitcnt lgkmcnt(4)
    v_mfma_f32_16x16x32_bf16 v[24:27], v[20:23], v[40:43], v[24:27]
    s_waitcnt lgkmcnt(2)
    v_mfma_f32_16x16x32_bf16 v[28:31], v[20:23], v[44:47], v[28:31]
    s_waitcnt lgkmcnt(0)
    v_mfma_f32_16x16x32_bf16 v[32:35], v[20:23], v[48:51], v[32:35]
    s_waitcnt vmcnt(21)
    s_waitcnt lgkmcnt(0)
    s_barrier
    v_add_u32 v2, 0, v16
    ds_read_b64_tr_b16 v[40:41], v2 offset:0
    ds_read_b64_tr_b16 v[42:43], v2 offset:768
    ds_read_b64_tr_b16 v[44:45], v2 offset:64
    ds_read_b64_tr_b16 v[46:47], v2 offset:832
    ds_read_b64_tr_b16 v[48:49], v2 offset:128
    ds_read_b64_tr_b16 v[50:51], v2 offset:896
    s_waitcnt lgkmcnt(4)
    v_mfma_f32_16x16x32_bf16 v[24:27], v[20:23], v[40:43], v[24:27]
    s_waitcnt lgkmcnt(2)
    v_mfma_f32_16x16x32_bf16 v[28:31], v[20:23], v[44:47], v[28:31]
    s_waitcnt lgkmcnt(0)
    v_mfma_f32_16x16x32_bf16 v[32:35], v[20:23], v[48:51], v[32:35]
    s_waitcnt vmcnt(14)
    s_waitcnt lgkmcnt(0)
    s_barrier
    v_add_u32 v2, 28672, v16
    ds_read_b64_tr_b16 v[40:41], v2 offset:0
    ds_read_b64_tr_b16 v[42:43], v2 offset:768
    ds_read_b64_tr_b16 v[44:45], v2 offset:64
    ds_read_b64_tr_b16 v[46:47], v2 offset:832
    ds_read_b64_tr_b16 v[48:49], v2 offset:128
    ds_read_b64_tr_b16 v[50:51], v2 offset:896
    s_waitcnt lgkmcnt(4)
    v_mfma_f32_16x16x32_bf16 v[24:27], v[20:23], v[40:43], v[24:27]
    s_waitcnt lgkmcnt(2)
    v_mfma_f32_16x16x32_bf16 v[28:31], v[20:23], v[44:47], v[28:31]
    s_waitcnt lgkmcnt(0)
    v_mfma_f32_16x16x32_bf16 v[32:35], v[20:23], v[48:51], v[32:35]
    s_nop 3
    v_and_b32 v40, 0xffff0000, v24
    v_sub_f32 v41, v24, v40
    v_and_b32 v42, 0xffff0000, v41
    v_sub_f32 v41, v41, v42
    v_lshrrev_b32 v40, 16, v40
    v_or_b32 v40, v40, v42
    v_lshrrev_b32 v41, 16, v41
    v_and_b32 v44, 0xffff0000, v25
    v_sub_f32 v45, v25, v44
    v_and_b32 v46, 0xffff0000, v45
    v_sub_f32 v45, v45, v46
    v_lshrrev_b32 v44, 16, v44
    v_or_b32 v44, v44, v46
    v_lshrrev_b32 v45, 16, v45
    v_and_b32 v48, 0xffff0000, v28
    v_sub_f32 v49, v28, v48
    v_and_b32 v50, 0xffff0000, v49
    v_sub_f32 v49, v49, v50
    v_lshrrev_b32 v48, 16, v48
    v_or_b32 v48, v48, v50
    v_lshrrev_b32 v49, 16, v49
    v_and_b32 v52, 0xffff0000, v29
    v_sub_f32 v53, v29, v52
    v_and_b32 v54, 0xffff0000, v53
    v_sub_f32 v53, v53, v54
    v_lshrrev_b32 v52, 16, v52
    v_or_b32 v52, v52, v54
    v_lshrrev_b32 v53, 16, v53
    v_and_b32 v56, 0xffff0000, v32
    v_sub_f32 v57, v32, v56
    v_and_b32 v58, 0xffff0000, v57
    v_sub_f32 v57, v57, v58
    v_lshrrev_b32 v56, 16, v56
    v_or_b32 v56, v56, v58
    v_lshrrev_b32 v57, 16, v57
    v_and_b32 v60, 0xffff0000, v33
    v_sub_f32 v61, v33, v60
    v_and_b32 v62, 0xffff0000, v61
    v_sub_f32 v61, v61, v62
    v_lshrrev_b32 v60, 16, v60
    v_or_b32 v60, v60, v62
    v_lshrrev_b32 v61, 16, v61
    s_mov_b64 exec, 0xffff
    ds_write_b64 v19, v[40:41] offset:0
    ds_write_b64 v19, v[44:45] offset:256
    ds_write_b64 v19, v[48:49] offset:1024
    ds_write_b64 v19, v[52:53] offset:1280
    ds_write_b64 v19, v[56:57] offset:2048
    ds_write_b64 v19, v[60:61] offset:2304
    s_mov_b64 exec, -1
    s_waitcnt lgkmcnt(0)
    s_barrier
    s_lshl_b32 s23, s20, 11
    s_add_u32 s23, s23, 28672
    v_add_u32 v124, s23, v1
    v_bfe_u32 v2, v0, 4, 1
    v_lshl_add_u32 v125, v2, 10, s23
    v_lshrrev_b32 v2, 5, v0
    v_lshl_add_u32 v125, v2, 6, v125
    v_bfe_u32 v2, v0, 2, 2
    v_lshl_add_u32 v125, v2, 4, v125
    v_and_b32 v2, 1, v0
    v_lshl_add_u32 v125, v2, 9, v125
    v_bfe_u32 v2, v0, 1, 1
    v_lshl_add_u32 v125, v2, 3, v125
    v_and_b32 v2, 31, v0
    v_cmp_gt_u32 vcc, 28, v2
    s_nop 1
    v_cndmask_b32 v126, 0, -1, vcc
    v_mov_b32 v3, 0x3f803f80
    v_cmp_eq_u32 vcc, 28, v2
    s_nop 1
    v_cndmask_b32 v127, 0, v3, vcc
    s_add_u32 s35, s21, s20
    s_waitcnt lgkmcnt(0)
    s_barrier
    v_mov_b32 v2, 154624
    ds_read_b32 v15, v2
    s_mul_i32 s27, s22, 3
    s_cmp_ge_u32 s27, 32
    s_cbranch_scc1 K_RV0s
    ds_read_b128 v[100:103], v124 offset:0
    ds_read_b128 v[104:107], v124 offset:1024
    s_branch K_RW0s
K_RV0s:
    ds_read_b64_tr_b16 v[100:101], v125 offset:0
    ds_read_b64_tr_b16 v[102:103], v125 offset:128
    ds_read_b64_tr_b16 v[104:105], v125 offset:256
    ds_read_b64_tr_b16 v[106:107], v125 offset:384
K_RW0s:
    s_cmp_ge_u32 s27, 31
    s_cbranch_scc1 K_RV1s
    ds_read_b128 v[108:111], v124 offset:8192
    ds_read_b128 v[112:115], v124 offset:9216
    s_branch K_RW1s
K_RV1s:
    ds_read_b64_tr_b16 v[108:109], v125 offset:8192
    ds_read_b64_tr_b16 v[110:111], v125 offset:8320
    ds_read_b64_tr_b16 v[112:113], v125 offset:8448
    ds_read_b64_tr_b16 v[114:115], v125 offset:8576
K_RW1s:
    s_cmp_ge_u32 s27, 30
    s_cbranch_scc1 K_RV2s
    ds_read_b128 v[116:119], v124 offset:16384
    ds_read_b128 v[120:123], v124 offset:17408
    s_branch K_RW2s
K_RV2s:
    ds_read_b64_tr_b16 v[116:117], v125 offset:16384
    ds_read_b64_tr_b16 v[118:119], v125 offset:16512
    ds_read_b64_tr_b16 v[120:121], v125 offset:16640
    ds_read_b64_tr_b16 v[122:123], v125 offset:16768
K_RW2s:
    s_waitcnt lgkmcnt(0)
    s_add_u32 s23, s27, 0
    s_lshr_b32 s24, s23, 4
    s_and_b32 s23, s23, 15
    s_lshl_b32 s23, s23, 6
    s_add_u32 s23, s23, s35
    s_lshl_b32 s26, s23, 11
    s_lshl_b32 s23, s23, 12
    s_add_u32 s23, s23, 2097152
    s_cmp_eq_u32 s24, 0
    s_cselect_b32 s26, s26, s23
    s_cselect_b32 s23, 0, 0x3f803f80
    s_cselect_b32 s34, 0, 0x3f80
    s_cmp_eq_u32 s24, 2
    s_cbranch_scc1 K_FV0s
    s_mov_b32 exec_lo, 0
    v_mov_b32 v106, s23
    v_mov_b32 v107, s34
    s_mov_b32 exec_lo, -1
    s_branch K_FW0s
K_FV0s:
    v_and_or_b32 v100, v100, v126, v127
    v_and_or_b32 v101, v101, v126, v127
    v_and_or_b32 v102, v102, v126, v127
    v_and_or_b32 v103, v103, v126, v127
    v_and_or_b32 v104, v104, v126, v127
    v_and_or_b32 v105, v105, v126, v127
    v_and_or_b32 v106, v106, v126, v127
    v_and_or_b32 v107, v107, v126, v127
    s_add_u32 s26, s26, 2048
K_FW0s:
    buffer_store_dwordx4 v[100:103], v1, s[16:19], s26 offen sc1
    buffer_store_dwordx4 v[104:107], v1, s[16:19], s26 offen offset:1024 sc1
    s_add_u32 s23, s27, 1
    s_lshr_b32 s24, s23, 4
    s_and_b32 s23, s23, 15
    s_lshl_b32 s23, s23, 6
    s_add_u32 s23, s23, s35
    s_lshl_b32 s26, s23, 11
    s_lshl_b32 s23, s23, 12
    s_add_u32 s23, s23, 2097152
    s_cmp_eq_u32 s24, 0
    s_cselect_b32 s26, s26, s23
    s_cselect_b32 s23, 0, 0x3f803f80
    s_cselect_b32 s34, 0, 0x3f80
    s_cmp_eq_u32 s24, 2
    s_cbranch_scc1 K_FV1s
    s_mov_b32 exec_lo, 0
    v_mov_b32 v114, s23
    v_mov_b32 v115, s34
    s_mov_b32 exec_lo, -1
    s_branch K_FW1s
K_FV1s:
    v_and_or_b32 v108, v108, v126, v127
    v_and_or_b32 v109, v109, v126, v127
    v_and_or_b32 v110, v110, v126, v127
    v_and_or_b32 v111, v111, v126, v127
    v_and_or_b32 v112, v112, v126, v127
    v_and_or_b32 v113, v113, v126, v127
    v_and_or_b32 v114, v114, v126, v127
    v_and_or_b32 v115, v115, v126, v127
    s_add_u32 s26, s26, 2048
K_FW1s:
    buffer_store_dwordx4 v[108:111], v1, s[16:19], s26 offen sc1
    buffer_store_dwordx4 v[112:115], v1, s[16:19], s26 offen offset:1024 sc1
    s_add_u32 s23, s27, 2
    s_lshr_b32 s24, s23, 4
    s_and_b32 s23, s23, 15
    s_lshl_b32 s23, s23, 6
    s_add_u32 s23, s23, s35
    s_lshl_b32 s26, s23, 11
    s_lshl_b32 s23, s23, 12
    s_add_u32 s23, s23, 2097152
    s_cmp_eq_u32 s24, 0
    s_cselect_b32 s26, s26, s23
    s_cselect_b32 s23, 0, 0x3f803f80
    s_cselect_b32 s34, 0, 0x3f80
    s_cmp_eq_u32 s24, 2
    s_cbranch_scc1 K_FV2s
    s_mov_b32 exec_lo, 0
    v_mov_b32 v122, s23
    v_mov_b32 v123, s34
    s_mov_b32 exec_lo, -1
    s_branch K_FW2s
K_FV2s:
    v_and_or_b32 v116, v116, v126, v127
    v_and_or_b32 v117, v117, v126, v127
    v_and_or_b32 v118, v118, v126, v127
    v_and_or_b32 v119, v119, v126, v127
    v_and_or_b32 v120, v120, v126, v127
    v_and_or_b32 v121, v121, v126, v127
    v_and_or_b32 v122, v122, v126, v127
    v_and_or_b32 v123, v123, v126, v127
    s_add_u32 s26, s26, 2048
K_FW2s:
    buffer_store_dwordx4 v[116:119], v1, s[16:19], s26 offen sc1
    buffer_store_dwordx4 v[120:123], v1, s[16:19], s26 offen offset:1024 sc1
    s_lshl_b32 s23, s22, 6
    s_add_u32 s23, s23, s35
    s_lshl_b32 s23, s23, 2
    s_add_u32 s23, s23, 18874368
    s_mov_b64 exec, 1
    s_waitcnt vmcnt(0)
    buffer_store_dword v15, v1, s[16:19], s23 offen sc1
    s_mov_b64 exec, -1
    s_lshl_b32 s23, s35, 4
    s_add_u32 s23, s23, s22
    s_lshl_b32 s23, s23, 2
    s_add_u32 s23, s23, 18878464
    s_mov_b64 exec, 1
    s_waitcnt vmcnt(0)
    buffer_store_dword v15, v1, s[16:19], s23 offen sc1
    s_mov_b64 exec, -1
    s_barrier
    s_cmp_ge_u32 s32, 112
    s_cbranch_scc1 K_GEMM
    s_lshl_b32 s25, s32, 10
    s_add_u32 s25, s25, 13631488
    v_lshrrev_b32 v2, 5, v0
    v_lshlrev_b32 v3, 2, v2
    v_bfe_u32 v2, v0, 2, 2
    v_add_u32 v3, v3, v2
    v_mul_u32_u24 v3, 896, v3
    v_bfe_u32 v2, v0, 4, 1
    v_lshl_add_u32 v3, v2, 5, v3
    v_and_b32 v2, 3, v0
    v_lshl_add_u32 v3, v2, 3, v3
    v_add_u32 v3, s30, v3
    v_mov_b32 v2, 154624
    s_waitcnt vmcnt(0)
    ds_read_b32 v4, v2
    ds_read_b64_tr_b16 v[40:41], v3 offset:0
    ds_read_b64_tr_b16 v[42:43], v3 offset:7168
    ds_read_b64_tr_b16 v[44:45], v3 offset:64
    ds_read_b64_tr_b16 v[46:47], v3 offset:7232
    ds_read_b64_tr_b16 v[48:49], v3 offset:128
    ds_read_b64_tr_b16 v[50:51], v3 offset:7296
    ds_read_b64_tr_b16 v[52:53], v3 offset:192
    ds_read_b64_tr_b16 v[54:55], v3 offset:7360
    ds_read_b64_tr_b16 v[56:57], v3 offset:256
    ds_read_b64_tr_b16 v[58:59], v3 offset:7424
    ds_read_b64_tr_b16 v[60:61], v3 offset:320
    ds_read_b64_tr_b16 v[62:63], v3 offset:7488
    ds_read_b64_tr_b16 v[64:65], v3 offset:384
    ds_read_b64_tr_b16 v[66:67], v3 offset:7552
    ds_read_b64_tr_b16 v[68:69], v3 offset:448
    ds_read_b64_tr_b16 v[70:71], v3 offset:7616
    ds_read_b64_tr_b16 v[72:73], v3 offset:512
    ds_read_b64_tr_b16 v[74:75], v3 offset:7680
    ds_read_b64_tr_b16 v[76:77], v3 offset:576
    ds_read_b64_tr_b16 v[78:79], v3 offset:7744
    ds_read_b64_tr_b16 v[80:81], v3 offset:640
    ds_read_b64_tr_b16 v[82:83], v3 offset:7808
    ds_read_b64_tr_b16 v[84:85], v3 offset:704
    ds_read_b64_tr_b16 v[86:87], v3 offset:7872
    ds_read_b64_tr_b16 v[88:89], v3 offset:768
    ds_read_b64_tr_b16 v[90:91], v3 offset:7936
    ds_read_b64_tr_b16 v[92:93], v3 offset:832
    ds_read_b64_tr_b16 v[94:95], v3 offset:8000
    s_waitcnt lgkmcnt(15)
    buffer_store_dwordx4 v[40:43], v1, s[16:19], s25 offen sc1
    s_add_u32 s25, s25, 114688
    buffer_store_dwordx4 v[44:47], v1, s[16:19], s25 offen sc1
    s_add_u32 s25, s25, 114688
    buffer_store_dwordx4 v[48:51], v1, s[16:19], s25 offen sc1
    s_add_u32 s25, s25, 114688
    buffer_store_dwordx4 v[52:55], v1, s[16:19], s25 offen sc1
    s_add_u32 s25, s25, 114688
    buffer_store_dwordx4 v[56:59], v1, s[16:19], s25 offen sc1
    s_add_u32 s25, s25, 114688
    buffer_store_dwordx4 v[60:63], v1, s[16:19], s25 offen sc1
    s_add_u32 s25, s25, 114688
    s_waitcnt lgkmcnt(14)
    buffer_store_dwordx4 v[64:67], v1, s[16:19], s25 offen sc1
    s_add_u32 s25, s25, 114688
    s_waitcnt lgkmcnt(12)
    buffer_store_dwordx4 v[68:71], v1, s[16:19], s25 offen sc1
    s_add_u32 s25, s25, 114688
    s_waitcnt lgkmcnt(10)
    buffer_store_dwordx4 v[72:75], v1, s[16:19], s25 offen sc1
    s_add_u32 s25, s25, 114688
    s_waitcnt lgkmcnt(8)
    buffer_store_dwordx4 v[76:79], v1, s[16:19], s25 offen sc1
    s_add_u32 s25, s25, 114688
    s_waitcnt lgkmcnt(6)
    buffer_store_dwordx4 v[80:83], v1, s[16:19], s25 offen sc1
    s_add_u32 s25, s25, 114688
    s_waitcnt lgkmcnt(4)
    buffer_store_dwordx4 v[84:87], v1, s[16:19], s25 offen sc1
    s_add_u32 s25, s25, 114688
    s_waitcnt lgkmcnt(2)
    buffer_store_dwordx4 v[88:91], v1, s[16:19], s25 offen sc1
    s_add_u32 s25, s25, 114688
    s_waitcnt lgkmcnt(0)
    buffer_store_dwordx4 v[92:95], v1, s[16:19], s25 offen sc1
    s_add_u32 s25, s25, 114688
    s_lshl_b32 s23, s32, 2
    s_add_u32 s23, s23, 18882560
    s_mov_b64 exec, 1
    s_waitcnt vmcnt(0) lgkmcnt(0)
    buffer_store_dword v4, v1, s[16:19], s23 offen sc1
    s_mov_b64 exec, -1
    s_branch K_GEMM
K_HWO:
    s_cmp_lg_u32 s22, 7
    s_cbranch_scc1 K_END
    s_cmp_ge_u32 s20, 2
    s_cbranch_scc1 K_END
    s_mov_b32 s8, s44
    s_and_b32 s9, s45, 0xffff
    s_mov_b32 s10, 401408
    s_mov_b32 s11, 0x00020000
    s_lshr_b32 s32, s21, 1
    s_add_u32 s32, s32, s20
    s_lshr_b32 s25, s21, 2
    s_mul_i32 s25, s25, 25088
    s_mul_i32 s23, s20, 14336
    s_add_u32 s25, s25, s23
    s_mul_i32 s30, s20, 14336
    s_add_u32 s30, s30, 57344
    s_add_u32 m0, s30, 0
    s_add_u32 s23, s25, 0
    buffer_load_dwordx4 v1, s[8:11], s23 offen offset:0 lds
    buffer_load_dwordx4 v1, s[8:11], s23 offen offset:1024 lds
    buffer_load_dwordx4 v1, s[8:11], s23 offen offset:2048 lds
    buffer_load_dwordx4 v1, s[8:11], s23 offen offset:3072 lds
    s_add_u32 m0, s30, 4096
    s_add_u32 s23, s25, 4096
    buffer_load_dwordx4 v1, s[8:11], s23 offen offset:0 lds
    buffer_load_dwordx4 v1, s[8:11], s23 offen offset:1024 lds
    buffer_load_dwordx4 v1, s[8:11], s23 offen offset:2048 lds
    buffer_load_dwordx4 v1, s[8:11], s23 offen offset:3072 lds
    s_add_u32 m0, s30, 8192
    s_add_u32 s23, s25, 8192
    buffer_load_dwordx4 v1, s[8:11], s23 offen offset:0 lds
    buffer_load_dwordx4 v1, s[8:11], s23 offen offset:1024 lds
    buffer_load_dwordx4 v1, s[8:11], s23 offen offset:2048 lds
    buffer_load_dwordx4 v1, s[8:11], s23 offen offset:3072 lds
    s_add_u32 m0, s30, 12288
    s_add_u32 s23, s25, 12288
    buffer_load_dwordx4 v1, s[8:11], s23 offen offset:0 lds
    buffer_load_dwordx4 v1, s[8:11], s23 offen offset:1024 lds
    s_lshl_b32 s25, s32, 10
    s_add_u32 s25, s25, 15728640
    s_add_u32 s32, s32, 128
    s_sub_u32 s24, 0, s20
    v_lshrrev_b32 v2, 5, v0
    v_lshlrev_b32 v3, 2, v2
    v_bfe_u32 v2, v0, 2, 2
    v_add_u32 v3, v3, v2
    v_mul_u32_u24 v3, 896, v3
    v_bfe_u32 v2, v0, 4, 1
    v_lshl_add_u32 v3, v2, 5, v3
    v_and_b32 v2, 3, v0
    v_lshl_add_u32 v3, v2, 3, v3
    v_add_u32 v3, s30, v3
    v_mov_b32 v2, 154624
    s_waitcnt vmcnt(0)
    ds_read_b32 v4, v2
    ds_read_b64_tr_b16 v[40:41], v3 offset:0
    ds_read_b64_tr_b16 v[42:43], v3 offset:7168
    ds_read_b64_tr_b16 v[44:45], v3 offset:64
    ds_read_b64_tr_b16 v[46:47], v3 offset:7232
    ds_read_b64_tr_b16 v[48:49], v3 offset:128
    ds_read_b64_tr_b16 v[50:51], v3 offset:7296
    ds_read_b64_tr_b16 v[52:53], v3 offset:192
    ds_read_b64_tr_b16 v[54:55], v3 offset:7360
    ds_read_b64_tr_b16 v[56:57], v3 offset:256
    ds_read_b64_tr_b16 v[58:59], v3 offset:7424
    ds_read_b64_tr_b16 v[60:61], v3 offset:320
    ds_read_b64_tr_b16 v[62:63], v3 offset:7488
    ds_read_b64_tr_b16 v[64:65], v3 offset:384
    ds_read_b64_tr_b16 v[66:67], v3 offset:7552
    ds_read_b64_tr_b16 v[68:69], v3 offset:448
    ds_read_b64_tr_b16 v[70:71], v3 offset:7616
    ds_read_b64_tr_b16 v[72:73], v3 offset:512
    ds_read_b64_tr_b16 v[74:75], v3 offset:7680
    ds_read_b64_tr_b16 v[76:77], v3 offset:576
    ds_read_b64_tr_b16 v[78:79], v3 offset:7744
    ds_read_b64_tr_b16 v[80:81], v3 offset:640
    ds_read_b64_tr_b16 v[82:83], v3 offset:7808
    ds_read_b64_tr_b16 v[84:85], v3 offset:704
    ds_read_b64_tr_b16 v[86:87], v3 offset:7872
    ds_read_b64_tr_b16 v[88:89], v3 offset:768
    ds_read_b64_tr_b16 v[90:91], v3 offset:7936
    ds_read_b64_tr_b16 v[92:93], v3 offset:832
    ds_read_b64_tr_b16 v[94:95], v3 offset:8000
    s_waitcnt lgkmcnt(0)
    s_mov_b32 exec_lo, 0
    s_mov_b32 exec_hi, s24
    v_mov_b32 v42, 0
    v_mov_b32 v43, 0
    v_mov_b32 v46, 0
    v_mov_b32 v47, 0
    v_mov_b32 v50, 0
    v_mov_b32 v51, 0
    v_mov_b32 v54, 0
    v_mov_b32 v55, 0
    v_mov_b32 v58, 0
    v_mov_b32 v59, 0
    v_mov_b32 v62, 0
    v_mov_b32 v63, 0
    v_mov_b32 v66, 0
    v_mov_b32 v67, 0
    v_mov_b32 v70, 0
    v_mov_b32 v71, 0
    v_mov_b32 v74, 0
    v_mov_b32 v75, 0
    v_mov_b32 v78, 0
    v_mov_b32 v79, 0
    v_mov_b32 v82, 0
    v_mov_b32 v83, 0
    v_mov_b32 v86, 0
    v_mov_b32 v87, 0
    v_mov_b32 v90, 0
    v_mov_b32 v91, 0
    v_mov_b32 v94, 0
    v_mov_b32 v95, 0
    s_mov_b64 exec, -1
    buffer_store_dwordx4 v[40:43], v1, s[16:19], s25 offen sc1
    s_add_u32 s25, s25, 32768
    buffer_store_dwordx4 v[44:47], v1, s[16:19], s25 offen sc1
    s_add_u32 s25, s25, 32768
    buffer_store_dwordx4 v[48:51], v1, s[16:19], s25 offen sc1
    s_add_u32 s25, s25, 32768
    buffer_store_dwordx4 v[52:55], v1, s[16:19], s25 offen sc1
    s_add_u32 s25, s25, 32768
    buffer_store_dwordx4 v[56:59], v1, s[16:19], s25 offen sc1
    s_add_u32 s25, s25, 32768
    buffer_store_dwordx4 v[60:63], v1, s[16:19], s25 offen sc1
    s_add_u32 s25, s25, 32768
    buffer_store_dwordx4 v[64:67], v1, s[16:19], s25 offen sc1
    s_add_u32 s25, s25, 32768
    buffer_store_dwordx4 v[68:71], v1, s[16:19], s25 offen sc1
    s_add_u32 s25, s25, 32768
    buffer_store_dwordx4 v[72:75], v1, s[16:19], s25 offen sc1
    s_add_u32 s25, s25, 32768
    buffer_store_dwordx4 v[76:79], v1, s[16:19], s25 offen sc1
    s_add_u32 s25, s25, 32768
    buffer_store_dwordx4 v[80:83], v1, s[16:19], s25 offen sc1
    s_add_u32 s25, s25, 32768
    buffer_store_dwordx4 v[84:87], v1, s[16:19], s25 offen sc1
    s_add_u32 s25, s25, 32768
    buffer_store_dwordx4 v[88:91], v1, s[16:19], s25 offen sc1
    s_add_u32 s25, s25, 32768
    buffer_store_dwordx4 v[92:95], v1, s[16:19], s25 offen sc1
    s_add_u32 s25, s25, 32768
    s_lshl_b32 s23, s32, 2
    s_add_u32 s23, s23, 18882560
    s_mov_b64 exec, 1
    s_waitcnt vmcnt(0) lgkmcnt(0)
    buffer_store_dword v4, v1, s[16:19], s23 offen sc1
    s_mov_b64 exec, -1
    s_endpgm
K_GEMM:
    s_setprio 0
    s_lshr_b32 s39, s37, 2
    s_cmp_ge_u32 s39, 7
    s_cbranch_scc1 K_HWO
    v_mov_b32 v2, 154624
    ds_read_b32 v3, v2
    s_lshl_b32 s38, s36, 2
    s_and_b32 s23, s37, 3
    s_add_u32 s38, s38, s23
    s_lshr_b32 s23, s20, 1
    s_lshl_b32 s21, s38, 1
    s_add_u32 s21, s21, s23
    s_and_b32 s23, s20, 1
    s_lshl_b32 s27, s39, 1
    s_add_u32 s27, s27, s23
    s_mul_i32 s23, s20, 28672
    s_mul_i32 s29, s27, 114688
    s_xor_b32 s24, s27, 1
    s_mul_i32 s32, s24, 114688
    s_mul_i32 s33, s21, 114688
    s_xor_b32 s24, s21, 1
    s_mul_i32 s30, s24, 114688
    s_add_u32 s24, s23, 13631488
    s_add_u32 s29, s29, s24
    s_add_u32 s32, s32, s24
    s_add_u32 s24, s23, 6291456
    s_add_u32 s33, s33, s24
    s_add_u32 s30, s30, s24
    s_waitcnt lgkmcnt(0)
    v_readfirstlane_b32 s34, v3
    v_and_b32 v7, 31, v0
    v_mul_u32_u24 v7, 896, v7
    v_lshrrev_b32 v6, 5, v0
    v_lshl_add_u32 v3, v6, 3, v7
    s_mul_i32 s25, s21, 28672
    s_lshl_b32 s24, s27, 6
    s_add_u32 s25, s25, s24
    buffer_load_dwordx2 v[120:121], v3, s[4:7], s25 offen offset:0
    buffer_load_dwordx2 v[122:123], v3, s[4:7], s25 offen offset:16
    buffer_load_dwordx2 v[124:125], v3, s[4:7], s25 offen offset:32
    buffer_load_dwordx2 v[126:127], v3, s[4:7], s25 offen offset:48
    v_lshl_add_u32 v2, v6, 4, v7
    v_mov_b64 v[128:129], 0
    v_mov_b64 v[130:131], 0
    v_mov_b64 v[132:133], 0
    v_mov_b64 v[134:135], 0
    v_mov_b64 v[136:137], 0
    v_mov_b64 v[138:139], 0
    v_mov_b64 v[140:141], 0
    v_mov_b64 v[142:143], 0
    v_mov_b64 v[144:145], 0
    v_mov_b64 v[146:147], 0
    v_mov_b64 v[148:149], 0
    v_mov_b64 v[150:151], 0
    v_mov_b64 v[152:153], 0
    v_mov_b64 v[154:155], 0
    v_mov_b64 v[156:157], 0
    v_mov_b64 v[158:159], 0
    v_mov_b64 v[160:161], 0
    v_mov_b64 v[162:163], 0
    v_mov_b64 v[164:165], 0
    v_mov_b64 v[166:167], 0
    v_mov_b64 v[168:169], 0
    v_mov_b64 v[170:171], 0
    v_mov_b64 v[172:173], 0
    v_mov_b64 v[174:175], 0
    s_xor_b32 s24, s20, 1
    s_mul_i32 s24, s24, 3
    s_add_u32 s24, s24, 12
    s_lshl_b32 s24, s24, 12
    v_add_u32 v3, s24, v1
    s_xor_b32 s24, s20, 2
    s_mul_i32 s24, s24, 3
    s_add_u32 s24, s24, 13
    s_lshl_b32 s24, s24, 12
    v_add_u32 v4, s24, v1
    s_xor_b32 s24, s20, 3
    s_mul_i32 s24, s24, 3
    s_add_u32 s24, s24, 14
    s_lshl_b32 s24, s24, 12
    v_add_u32 v5, s24, v1
    s_mul_i32 s24, s20, 12288
    s_add_u32 s24, s24, 49152
    v_add_u32 v6, s24, v1
    s_waitcnt vmcnt(3)
    v_lshlrev_b32 v8, 16, v120
    v_and_b32 v9, 0xffff0000, v120
    v_lshlrev_b32 v10, 16, v121
    v_and_b32 v11, 0xffff0000, v121
    s_waitcnt vmcnt(2)
    v_lshlrev_b32 v12, 16, v122
    v_and_b32 v13, 0xffff0000, v122
    v_lshlrev_b32 v14, 16, v123
    v_and_b32 v15, 0xffff0000, v123
    s_waitcnt vmcnt(1)
    v_lshlrev_b32 v16, 16, v124
    v_and_b32 v17, 0xffff0000, v124
    v_lshlrev_b32 v18, 16, v125
    v_and_b32 v19, 0xffff0000, v125
    s_waitcnt vmcnt(0)
    v_lshlrev_b32 v20, 16, v126
    v_and_b32 v21, 0xffff0000, v126
    v_lshlrev_b32 v22, 16, v127
    v_and_b32 v23, 0xffff0000, v127
    s_mov_b32 s12, s52
    s_and_b32 s13, s53, 0xffff
    s_mov_b32 s14, 1835008
    s_mov_b32 s15, 0x00020000
    v_mov_b32 v24, 154628
    v_mov_b32 v25, s34
    s_cmp_lg_u32 s20, 0
    s_cbranch_scc1 K_PL
    v_and_b32 v7, 7, v0
    s_lshl_b32 s23, s38, 7
    s_add_u32 s23, s23, 18878464
    v_lshl_add_u32 v7, v7, 4, s23
    s_mov_b64 exec, 0xfffffff
    v_add_u32 v7, 18882560, v1
    s_mov_b64 exec, -1
    s_mov_b32 s35, 262144
K_PH:
    buffer_load_dwordx4 v[120:123], v7, s[16:19], 0 offen sc1
    s_sub_u32 s35, s35, 1
    s_cmp_eq_u32 s35, 0
    s_waitcnt vmcnt(0)
    s_cbranch_scc1 K_PHX
    v_xor_b32 v120, s34, v120
    v_xor_b32 v121, s34, v121
    v_xor_b32 v122, s34, v122
    v_xor_b32 v123, s34, v123
    v_or3_b32 v120, v120, v121, v122
    v_or_b32 v120, v120, v123
    v_cmp_ne_u32 vcc, 0, v120
    s_nop 1
    s_cbranch_vccz K_PHX
    s_sleep 8
    s_branch K_PH
K_PHX:
    ds_write_b32 v24, v25
    s_branch K_PLX
K_PL:
    s_mov_b32 s35, 1048576
K_PL1:
    s_sleep 8
    ds_read_b32 v26, v24
    s_sub_u32 s35, s35, 1
    s_cmp_eq_u32 s35, 0
    s_waitcnt lgkmcnt(0)
    s_cbranch_scc1 K_PLX
    v_cmp_ne_u32 vcc, s34, v26
    s_nop 1
    s_cbranch_vccnz K_PL1
K_PLX:
    s_waitcnt lgkmcnt(0)
    buffer_load_dwordx4 v[24:27], v1, s[16:19], s29 offen offset:0 sc1
    buffer_load_dwordx4 v[28:31], v1, s[16:19], s32 offen offset:0 sc1
    buffer_load_dwordx4 v[32:35], v1, s[16:19], s33 offen offset:0 sc1
    buffer_load_dwordx4 v[36:39], v1, s[16:19], s30 offen offset:0 sc1
    buffer_load_dwordx4 v[40:43], v1, s[16:19], s29 offen offset:1024 sc1
    buffer_load_dwordx4 v[44:47], v1, s[16:19], s32 offen offset:1024 sc1
    buffer_load_dwordx4 v[48:51], v1, s[16:19], s33 offen offset:1024 sc1
    buffer_load_dwordx4 v[52:55], v1, s[16:19], s30 offen offset:1024 sc1
    s_add_u32 s29, s29, 2048
    s_add_u32 s32, s32, 2048
    s_add_u32 s33, s33, 2048
    s_add_u32 s30, s30, 2048
    s_mov_b32 s35, 13
K_GL:
    s_waitcnt vmcnt(5)
    v_mfma_f32_32x32x16_bf16 v[128:143], v[28:31], v[32:35], v[128:143]
    s_waitcnt vmcnt(4)
    v_mfma_f32_32x32x16_bf16 v[144:159], v[24:27], v[36:39], v[144:159]
    v_mfma_f32_32x32x16_bf16 v[160:175], v[28:31], v[36:39], v[160:175]
    v_mfma_f32_32x32x16_bf16 v[8:23], v[24:27], v[32:35], v[8:23]
    buffer_load_dwordx4 v[24:27], v1, s[16:19], s29 offen offset:0 sc1
    buffer_load_dwordx4 v[28:31], v1, s[16:19], s32 offen offset:0 sc1
    buffer_load_dwordx4 v[32:35], v1, s[16:19], s33 offen offset:0 sc1
    buffer_load_dwordx4 v[36:39], v1, s[16:19], s30 offen offset:0 sc1
    s_waitcnt vmcnt(5)
    v_mfma_f32_32x32x16_bf16 v[128:143], v[44:47], v[48:51], v[128:143]
    s_waitcnt vmcnt(4)
    v_mfma_f32_32x32x16_bf16 v[144:159], v[40:43], v[52:55], v[144:159]
    v_mfma_f32_32x32x16_bf16 v[160:175], v[44:47], v[52:55], v[160:175]
    v_mfma_f32_32x32x16_bf16 v[8:23], v[40:43], v[48:51], v[8:23]
    buffer_load_dwordx4 v[40:43], v1, s[16:19], s29 offen offset:1024 sc1
    buffer_load_dwordx4 v[44:47], v1, s[16:19], s32 offen offset:1024 sc1
    buffer_load_dwordx4 v[48:51], v1, s[16:19], s33 offen offset:1024 sc1
    buffer_load_dwordx4 v[52:55], v1, s[16:19], s30 offen offset:1024 sc1
    s_add_u32 s29, s29, 2048
    s_add_u32 s32, s32, 2048
    s_add_u32 s33, s33, 2048
    s_add_u32 s30, s30, 2048
    s_sub_u32 s35, s35, 1
    s_cmp_lg_u32 s35, 0
    s_cbranch_scc1 K_GL
    s_lshl_b32 s23, s20, 13
    s_lshl_b32 s29, s27, 15
    s_add_u32 s29, s29, s23
    s_add_u32 s29, s29, 15728640
    s_xor_b32 s32, s29, 0x8000
    s_lshl_b32 s33, s21, 15
    s_add_u32 s33, s33, s23
    s_add_u32 s33, s33, 16777216
    s_xor_b32 s30, s33, 0x8000
    v_and_b32 v7, 7, v0
    s_lshl_b32 s23, s20, 5
    s_add_u32 s23, s23, 18883072
    v_lshl_add_u32 v7, v7, 2, s23
    buffer_load_dword v120, v7, s[16:19], 0 offen sc1
    s_waitcnt vmcnt(6)
    v_mfma_f32_32x32x16_bf16 v[128:143], v[28:31], v[32:35], v[128:143]
    s_waitcnt vmcnt(5)
    v_mfma_f32_32x32x16_bf16 v[144:159], v[24:27], v[36:39], v[144:159]
    v_mfma_f32_32x32x16_bf16 v[160:175], v[28:31], v[36:39], v[160:175]
    v_mfma_f32_32x32x16_bf16 v[8:23], v[24:27], v[32:35], v[8:23]
    s_waitcnt vmcnt(2)
    v_mfma_f32_32x32x16_bf16 v[128:143], v[44:47], v[48:51], v[128:143]
    s_waitcnt vmcnt(1)
    v_mfma_f32_32x32x16_bf16 v[144:159], v[40:43], v[52:55], v[144:159]
    v_mfma_f32_32x32x16_bf16 v[160:175], v[44:47], v[52:55], v[160:175]
    v_mfma_f32_32x32x16_bf16 v[8:23], v[40:43], v[48:51], v[8:23]
    s_waitcnt vmcnt(0)
    v_cmp_ne_u32 vcc, s34, v120
    s_nop 1
    s_cbranch_vccz K_PWOX
    s_mov_b32 s35, 262144
K_PWO:
    s_sleep 24
    buffer_load_dword v120, v7, s[16:19], 0 offen sc1
    s_sub_u32 s35, s35, 1
    s_cmp_eq_u32 s35, 0
    s_waitcnt vmcnt(0)
    s_cbranch_scc1 K_PWOX
    v_cmp_ne_u32 vcc, s34, v120
    s_nop 1
    s_cbranch_vccnz K_PWO
K_PWOX:
    buffer_load_dwordx4 v[176:179], v1, s[16:19], s29 offen offset:0 sc1
    buffer_load_dwordx4 v[180:183], v1, s[16:19], s32 offen offset:0 sc1
    buffer_load_dwordx4 v[184:187], v1, s[16:19], s29 offen offset:1024 sc1
    buffer_load_dwordx4 v[188:191], v1, s[16:19], s32 offen offset:1024 sc1
    buffer_load_dwordx4 v[192:195], v1, s[16:19], s29 offen offset:2048 sc1
    buffer_load_dwordx4 v[196:199], v1, s[16:19], s32 offen offset:2048 sc1
    buffer_load_dwordx4 v[200:203], v1, s[16:19], s29 offen offset:3072 sc1
    buffer_load_dwordx4 v[204:207], v1, s[16:19], s32 offen offset:3072 sc1
    s_add_u32 s29, s29, 4096
    s_add_u32 s32, s32, 4096
    buffer_load_dwordx4 v[208:211], v1, s[16:19], s29 offen offset:0 sc1
    buffer_load_dwordx4 v[212:215], v1, s[16:19], s32 offen offset:0 sc1
    buffer_load_dwordx4 v[216:219], v1, s[16:19], s29 offen offset:1024 sc1
    buffer_load_dwordx4 v[220:223], v1, s[16:19], s32 offen offset:1024 sc1
    buffer_load_dwordx4 v[224:227], v1, s[16:19], s29 offen offset:2048 sc1
    buffer_load_dwordx4 v[228:231], v1, s[16:19], s32 offen offset:2048 sc1
    buffer_load_dwordx4 v[232:235], v1, s[16:19], s29 offen offset:3072 sc1
    buffer_load_dwordx4 v[236:239], v1, s[16:19], s32 offen offset:3072 sc1
    s_cmp_lg_u32 s20, 0
    s_cbranch_scc1 K_POX
    v_and_b32 v7, 3, v0
    v_lshlrev_b32 v7, 2, v7
    v_add_u32 v7, 154640, v7
    s_mov_b32 s35, 1048576
K_PA:
    s_sleep 8
    ds_read_b32 v120, v7
    s_sub_u32 s35, s35, 1
    s_cmp_eq_u32 s35, 0
    s_waitcnt lgkmcnt(0)
    s_cbranch_scc1 K_PAX
    v_cmp_ne_u32 vcc, s34, v120
    s_nop 1
    s_cbranch_vccnz K_PA
K_PAX:
    v_and_b32 v7, 31, v0
    v_lshlrev_b32 v7, 2, v7
    s_lshl_b32 s23, s38, 7
    s_add_u32 s23, s23, 18886656
    s_mov_b32 s35, 262144
K_PO:
    s_sleep 8
    buffer_load_dword v120, v7, s[16:19], s23 offen sc1
    s_sub_u32 s35, s35, 1
    s_cmp_eq_u32 s35, 0
    s_waitcnt vmcnt(0)
    s_cbranch_scc1 K_POX
    v_cmp_ne_u32 vcc, s34, v120
    s_nop 1
    s_cbranch_vccnz K_PO
K_POX:
    s_barrier
    buffer_load_dwordx4 v[24:27], v1, s[16:19], s33 offen offset:0 sc1
    buffer_load_dwordx4 v[28:31], v1, s[16:19], s30 offen offset:0 sc1
    buffer_load_dwordx4 v[32:35], v1, s[16:19], s33 offen offset:1024 sc1
    buffer_load_dwordx4 v[36:39], v1, s[16:19], s30 offen offset:1024 sc1
    buffer_load_dwordx4 v[40:43], v1, s[16:19], s33 offen offset:2048 sc1
    buffer_load_dwordx4 v[44:47], v1, s[16:19], s30 offen offset:2048 sc1
    buffer_load_dwordx4 v[48:51], v1, s[16:19], s33 offen offset:3072 sc1
    buffer_load_dwordx4 v[52:55], v1, s[16:19], s30 offen offset:3072 sc1
    s_add_u32 s33, s33, 4096
    s_add_u32 s30, s30, 4096
    buffer_load_dwordx4 v[56:59], v1, s[16:19], s33 offen offset:0 sc1
    buffer_load_dwordx4 v[60:63], v1, s[16:19], s30 offen offset:0 sc1
    buffer_load_dwordx4 v[64:67], v1, s[16:19], s33 offen offset:1024 sc1
    buffer_load_dwordx4 v[68:71], v1, s[16:19], s30 offen offset:1024 sc1
    buffer_load_dwordx4 v[72:75], v1, s[16:19], s33 offen offset:2048 sc1
    buffer_load_dwordx4 v[76:79], v1, s[16:19], s30 offen offset:2048 sc1
    buffer_load_dwordx4 v[80:83], v1, s[16:19], s33 offen offset:3072 sc1
    buffer_load_dwordx4 v[84:87], v1, s[16:19], s30 offen offset:3072 sc1
    s_waitcnt vmcnt(15)
    v_mfma_f32_32x32x16_bf16 v[128:143], v[180:183], v[24:27], v[128:143]
    s_waitcnt vmcnt(14)
    v_mfma_f32_32x32x16_bf16 v[144:159], v[176:179], v[28:31], v[144:159]
    v_mfma_f32_32x32x16_bf16 v[160:175], v[180:183], v[28:31], v[160:175]
    v_mfma_f32_32x32x16_bf16 v[8:23], v[176:179], v[24:27], v[8:23]
    s_waitcnt vmcnt(13)
    v_mfma_f32_32x32x16_bf16 v[128:143], v[188:191], v[32:35], v[128:143]
    s_waitcnt vmcnt(12)
    v_mfma_f32_32x32x16_bf16 v[144:159], v[184:187], v[36:39], v[144:159]
    v_mfma_f32_32x32x16_bf16 v[160:175], v[188:191], v[36:39], v[160:175]
    v_mfma_f32_32x32x16_bf16 v[8:23], v[184:187], v[32:35], v[8:23]
    s_waitcnt vmcnt(11)
    v_mfma_f32_32x32x16_bf16 v[128:143], v[196:199], v[40:43], v[128:143]
    s_waitcnt vmcnt(10)
    v_mfma_f32_32x32x16_bf16 v[144:159], v[192:195], v[44:47], v[144:159]
    v_mfma_f32_32x32x16_bf16 v[160:175], v[196:199], v[44:47], v[160:175]
    v_mfma_f32_32x32x16_bf16 v[8:23], v[192:195], v[40:43], v[8:23]
    s_waitcnt vmcnt(9)
    v_mfma_f32_32x32x16_bf16 v[128:143], v[204:207], v[48:51], v[128:143]
    s_waitcnt vmcnt(8)
    v_mfma_f32_32x32x16_bf16 v[144:159], v[200:203], v[52:55], v[144:159]
    v_mfma_f32_32x32x16_bf16 v[160:175], v[204:207], v[52:55], v[160:175]
    v_mfma_f32_32x32x16_bf16 v[8:23], v[200:203], v[48:51], v[8:23]
    s_waitcnt vmcnt(7)
    v_mfma_f32_32x32x16_bf16 v[128:143], v[212:215], v[56:59], v[128:143]
    s_waitcnt vmcnt(6)
    v_mfma_f32_32x32x16_bf16 v[144:159], v[208:211], v[60:63], v[144:159]
    v_mfma_f32_32x32x16_bf16 v[160:175], v[212:215], v[60:63], v[160:175]
    v_mfma_f32_32x32x16_bf16 v[8:23], v[208:211], v[56:59], v[8:23]
    s_waitcnt vmcnt(5)
    v_mfma_f32_32x32x16_bf16 v[128:143], v[220:223], v[64:67], v[128:143]
    s_waitcnt vmcnt(4)
    v_mfma_f32_32x32x16_bf16 v[144:159], v[216:219], v[68:71], v[144:159]
    v_mfma_f32_32x32x16_bf16 v[160:175], v[220:223], v[68:71], v[160:175]
    v_mfma_f32_32x32x16_bf16 v[8:23], v[216:219], v[64:67], v[8:23]
    s_waitcnt vmcnt(3)
    v_mfma_f32_32x32x16_bf16 v[128:143], v[228:231], v[72:75], v[128:143]
    s_waitcnt vmcnt(2)
    v_mfma_f32_32x32x16_bf16 v[144:159], v[224:227], v[76:79], v[144:159]
    v_mfma_f32_32x32x16_bf16 v[160:175], v[228:231], v[76:79], v[160:175]
    v_mfma_f32_32x32x16_bf16 v[8:23], v[224:227], v[72:75], v[8:23]
    s_waitcnt vmcnt(1)
    v_mfma_f32_32x32x16_bf16 v[128:143], v[236:239], v[80:83], v[128:143]
    s_waitcnt vmcnt(0)
    v_mfma_f32_32x32x16_bf16 v[144:159], v[232:235], v[84:87], v[144:159]
    v_mfma_f32_32x32x16_bf16 v[160:175], v[236:239], v[84:87], v[160:175]
    v_mfma_f32_32x32x16_bf16 v[8:23], v[232:235], v[80:83], v[8:23]
    s_nop 7
    ds_write_b128 v3, v[128:131] offset:0
    ds_write_b128 v3, v[132:135] offset:1024
    ds_write_b128 v3, v[136:139] offset:2048
    ds_write_b128 v3, v[140:143] offset:3072
    ds_write_b128 v4, v[144:147] offset:0
    ds_write_b128 v4, v[148:151] offset:1024
    ds_write_b128 v4, v[152:155] offset:2048
    ds_write_b128 v4, v[156:159] offset:3072
    ds_write_b128 v5, v[160:163] offset:0
    ds_write_b128 v5, v[164:167] offset:1024
    ds_write_b128 v5, v[168:171] offset:2048
    ds_write_b128 v5, v[172:175] offset:3072
    s_waitcnt lgkmcnt(0)
    s_barrier
    ds_read_b128 v[24:27], v6 offset:0
    ds_read_b128 v[28:31], v6 offset:1024
    ds_read_b128 v[32:35], v6 offset:2048
    ds_read_b128 v[36:39], v6 offset:3072
    ds_read_b128 v[40:43], v6 offset:4096
    ds_read_b128 v[44:47], v6 offset:5120
    ds_read_b128 v[48:51], v6 offset:6144
    ds_read_b128 v[52:55], v6 offset:7168
    ds_read_b128 v[56:59], v6 offset:8192
    ds_read_b128 v[60:63], v6 offset:9216
    ds_read_b128 v[64:67], v6 offset:10240
    ds_read_b128 v[68:71], v6 offset:11264
    s_waitcnt lgkmcnt(11)
    v_pk_add_f32 v[8:9], v[8:9], v[24:25]
    v_pk_add_f32 v[10:11], v[10:11], v[26:27]
    s_waitcnt lgkmcnt(10)
    v_pk_add_f32 v[12:13], v[12:13], v[28:29]
    v_pk_add_f32 v[14:15], v[14:15], v[30:31]
    s_waitcnt lgkmcnt(9)
    v_pk_add_f32 v[16:17], v[16:17], v[32:33]
    v_pk_add_f32 v[18:19], v[18:19], v[34:35]
    s_waitcnt lgkmcnt(8)
    v_pk_add_f32 v[20:21], v[20:21], v[36:37]
    v_pk_add_f32 v[22:23], v[22:23], v[38:39]
    s_waitcnt lgkmcnt(7)
    v_pk_add_f32 v[8:9], v[8:9], v[40:41]
    v_pk_add_f32 v[10:11], v[10:11], v[42:43]
    s_waitcnt lgkmcnt(6)
    v_pk_add_f32 v[12:13], v[12:13], v[44:45]
    v_pk_add_f32 v[14:15], v[14:15], v[46:47]
    s_waitcnt lgkmcnt(5)
    v_pk_add_f32 v[16:17], v[16:17], v[48:49]
    v_pk_add_f32 v[18:19], v[18:19], v[50:51]
    s_waitcnt lgkmcnt(4)
    v_pk_add_f32 v[20:21], v[20:21], v[52:53]
    v_pk_add_f32 v[22:23], v[22:23], v[54:55]
    s_waitcnt lgkmcnt(3)
    v_pk_add_f32 v[8:9], v[8:9], v[56:57]
    v_pk_add_f32 v[10:11], v[10:11], v[58:59]
    s_waitcnt lgkmcnt(2)
    v_pk_add_f32 v[12:13], v[12:13], v[60:61]
    v_pk_add_f32 v[14:15], v[14:15], v[62:63]
    s_waitcnt lgkmcnt(1)
    v_pk_add_f32 v[16:17], v[16:17], v[64:65]
    v_pk_add_f32 v[18:19], v[18:19], v[66:67]
    s_waitcnt lgkmcnt(0)
    v_pk_add_f32 v[20:21], v[20:21], v[68:69]
    v_pk_add_f32 v[22:23], v[22:23], v[70:71]
    v_cvt_pk_bf16_f32 v120, v8, v9
    v_cvt_pk_bf16_f32 v121, v10, v11
    v_cvt_pk_bf16_f32 v122, v12, v13
    v_cvt_pk_bf16_f32 v123, v14, v15
    v_cvt_pk_bf16_f32 v124, v16, v17
    v_cvt_pk_bf16_f32 v125, v18, v19
    v_cvt_pk_bf16_f32 v126, v20, v21
    v_cvt_pk_bf16_f32 v127, v22, v23
    v_permlane32_swap_b32 v120, v122
    v_permlane32_swap_b32 v121, v123
    v_permlane32_swap_b32 v124, v126
    v_permlane32_swap_b32 v125, v127
    buffer_store_dwordx4 v[120:123], v2, s[12:15], s25 offen offset:0
    buffer_store_dwordx4 v[124:127], v2, s[12:15], s25 offen offset:32
K_END:
    s_endpgm
K_COMP:
    s_waitcnt lgkmcnt(0)
    s_mov_b32 s16, s46
    s_and_b32 s17, s47, 0xffff
    s_mov_b32 s18, 19922944
    s_mov_b32 s19, 0x00020000
    s_add_u32 s21, s21, s20
    v_lshrrev_b32 v7, 5, v0
    v_lshlrev_b32 v7, 3, v7
    v_bfe_u32 v8, v0, 2, 2
    v_add_u32 v7, v7, v8
    v_bfe_u32 v8, v0, 4, 1
    v_lshlrev_b32 v2, 5, v8
    v_and_b32 v8, 3, v0
    v_lshl_add_u32 v2, v8, 3, v2
    v_mul_u32_u24 v92, 192, v7
    v_add_u32 v92, v92, v2
    v_lshl_add_u32 v2, v7, 7, v2
    v_bfe_u32 v8, v0, 3, 1
    v_lshl_add_u32 v2, v8, 6, v2
    v_xor_b32 v3, 64, v2
    v_lshrrev_b32 v14, 5, v0
    v_and_b32 v13, 31, v0
    v_bfe_u32 v7, v0, 1, 3
    v_xor_b32 v7, v14, v7
    s_lshl_b32 s23, s20, 12
    s_add_u32 s23, s23, 12288
    v_lshl_add_u32 v8, v13, 7, s23
    v_lshlrev_b32 v1, 4, v0
    v_xor_b32 v88, 0, v7
    v_lshl_add_u32 v88, v88, 4, v8
    v_xor_b32 v89, 2, v7
    v_lshl_add_u32 v89, v89, 4, v8
    v_xor_b32 v90, 4, v7
    v_lshl_add_u32 v90, v90, 4, v8
    v_xor_b32 v91, 6, v7
    v_lshl_add_u32 v91, v91, 4, v8
    v_and_b32 v7, 15, v0
    v_bfe_u32 v8, v0, 4, 1
    v_mov_b32 v6, 0x3f803f80
    v_cmp_eq_u32 vcc, v7, v8
    s_nop 1
    v_cndmask_b32 v84, 0, v6, vcc
    v_mov_b32 v85, v84
    v_mov_b32 v86, v84
    v_mov_b32 v87, v84
    v_add_u32 v6, 143360, v1
    v_mov_b64 v[64:65], 0
    v_mov_b64 v[66:67], 0
    v_mov_b64 v[68:69], 0
    v_mov_b64 v[70:71], 0
    s_mov_b32 s31, 0x3f803f80
    s_mul_i32 s30, s22, 3
    s_lshl_b32 s23, s20, 10
    s_add_u32 s23, s23, 150528
    v_lshl_add_u32 v94, v13, 4, s23
    v_and_b32 v7, 3, v0
    v_lshl_add_u32 v95, v7, 2, v94
    s_lshl_b32 s23, s20, 11
    s_add_u32 s23, s23, 28672
    v_add_u32 v9, s23, v1
    s_lshl_b32 s38, s36, 1
    s_and_b32 s23, s37, 1
    s_add_u32 s38, s38, s23
    s_lshr_b32 s39, s37, 1
    s_add_u32 s23, s38, 16
    s_mul_i32 s23, s23, 43
    s_lshr_b32 s23, s23, 7
    s_lshl_b32 s23, s23, 8
    v_mov_b32 v15, s23
    s_lshl_b32 s24, s20, 6
    s_add_u32 s23, s23, s24
    v_and_b32 v7, 15, v0
    s_mov_b64 exec, 0xffff
    v_lshl_add_u32 v15, v7, 2, s23
    s_add_u32 s23, s38, 32
    s_mul_i32 s23, s23, 43
    s_lshr_b32 s23, s23, 7
    s_lshl_b32 s23, s23, 8
    s_add_u32 s23, s23, s24
    s_mov_b32 exec_lo, 0xffff0000
    v_lshl_add_u32 v15, v7, 2, s23
    s_mul_i32 s23, s38, 43
    s_lshr_b32 s23, s23, 7
    s_lshl_b32 s23, s23, 8
    s_lshl_b32 s24, s39, 4
    s_add_u32 s23, s23, s24
    s_mov_b32 exec_lo, 0
    s_mov_b32 exec_hi, 15
    v_lshl_add_u32 v15, v7, 2, s23
    s_mov_b64 exec, -1
    v_add_u32 v15, 18874368, v15
    s_waitcnt lgkmcnt(0)
    s_barrier
    v_add_u32 v4, 0, v92
    v_add_u32 v93, 0, v88
    ds_read_b128 v[128:131], v93
    v_add_u32 v93, 0, v89
    ds_read_b128 v[132:135], v93
    v_add_u32 v93, 0, v90
    ds_read_b128 v[136:139], v93
    v_add_u32 v93, 0, v91
    ds_read_b128 v[140:143], v93
    ds_read_b64_tr_b16 v[96:97], v4 offset:0
    ds_read_b64_tr_b16 v[98:99], v4 offset:768
    ds_read_b64_tr_b16 v[100:101], v4 offset:64
    ds_read_b64_tr_b16 v[102:103], v4 offset:832
    ds_read_b64_tr_b16 v[104:105], v4 offset:128
    ds_read_b64_tr_b16 v[106:107], v4 offset:896
    ds_read_b64_tr_b16 v[108:109], v4 offset:3072
    ds_read_b64_tr_b16 v[110:111], v4 offset:3840
    ds_read_b64_tr_b16 v[112:113], v4 offset:3136
    ds_read_b64_tr_b16 v[114:115], v4 offset:3904
    ds_read_b64_tr_b16 v[116:117], v4 offset:3200
    ds_read_b64_tr_b16 v[118:119], v4 offset:3968
    ds_read_b64_tr_b16 v[120:121], v4 offset:6144
    ds_read_b64_tr_b16 v[122:123], v4 offset:6912
    s_waitcnt lgkmcnt(12)
    v_mfma_f32_32x32x16_bf16 v[16:31], v[96:99], v[128:131], 0
    ds_read_b64_tr_b16 v[124:125], v4 offset:6208
    ds_read_b64_tr_b16 v[126:127], v4 offset:6976
    s_waitcnt lgkmcnt(12)
    v_mfma_f32_32x32x16_bf16 v[32:47], v[100:103], v[128:131], 0
    ds_read_b64_tr_b16 v[96:97], v4 offset:6272
    ds_read_b64_tr_b16 v[98:99], v4 offset:7040
    s_waitcnt lgkmcnt(12)
    v_mfma_f32_32x32x16_bf16 v[48:63], v[104:107], v[128:131], 0
    ds_read_b64_tr_b16 v[100:101], v4 offset:9216
    ds_read_b64_tr_b16 v[102:103], v4 offset:9984
    s_waitcnt lgkmcnt(12)
    v_mfma_f32_32x32x16_bf16 v[16:31], v[108:111], v[132:135], v[16:31]
    ds_read_b64_tr_b16 v[104:105], v4 offset:9280
    ds_read_b64_tr_b16 v[106:107], v4 offset:10048
    s_waitcnt lgkmcnt(12)
    v_mfma_f32_32x32x16_bf16 v[32:47], v[112:115], v[132:135], v[32:47]
    ds_read_b64_tr_b16 v[108:109], v4 offset:9344
    ds_read_b64_tr_b16 v[110:111], v4 offset:10112
    s_waitcnt lgkmcnt(12)
    v_mfma_f32_32x32x16_bf16 v[48:63], v[116:119], v[132:135], v[48:63]
    s_waitcnt lgkmcnt(10)
    v_mfma_f32_32x32x16_bf16 v[16:31], v[120:123], v[136:139], v[16:31]
    s_waitcnt lgkmcnt(0)
    s_barrier
    v_add_u32 v4, 28672, v92
    v_add_u32 v93, 28672, v88
    ds_read_b128 v[144:147], v93
    v_add_u32 v93, 28672, v89
    ds_read_b128 v[148:151], v93
    v_mfma_f32_32x32x16_bf16 v[32:47], v[124:127], v[136:139], v[32:47]
    v_add_u32 v93, 28672, v90
    ds_read_b128 v[152:155], v93
    v_add_u32 v93, 28672, v91
    ds_read_b128 v[156:159], v93
    v_mfma_f32_32x32x16_bf16 v[48:63], v[96:99], v[136:139], v[48:63]
    ds_read_b64_tr_b16 v[112:113], v4 offset:0
    ds_read_b64_tr_b16 v[114:115], v4 offset:768
    ds_read_b64_tr_b16 v[116:117], v4 offset:64
    ds_read_b64_tr_b16 v[118:119], v4 offset:832
    v_mfma_f32_32x32x16_bf16 v[16:31], v[100:103], v[140:143], v[16:31]
    ds_read_b64_tr_b16 v[120:121], v4 offset:128
    ds_read_b64_tr_b16 v[122:123], v4 offset:896
    ds_read_b64_tr_b16 v[124:125], v4 offset:3072
    ds_read_b64_tr_b16 v[126:127], v4 offset:3840
    v_mfma_f32_32x32x16_bf16 v[32:47], v[104:107], v[140:143], v[32:47]
    ds_read_b64_tr_b16 v[96:97], v4 offset:3136
    ds_read_b64_tr_b16 v[98:99], v4 offset:3904
    ds_read_b64_tr_b16 v[100:101], v4 offset:3200
    ds_read_b64_tr_b16 v[102:103], v4 offset:3968
    v_mfma_f32_32x32x16_bf16 v[48:63], v[108:111], v[140:143], v[48:63]
    ds_read_b64_tr_b16 v[104:105], v4 offset:6144
    ds_read_b64_tr_b16 v[106:107], v4 offset:6912
    v_dot2c_f32_bf16 v64, s31, v128
    v_dot2c_f32_bf16 v68, v128, v128
    v_dot2c_f32_bf16 v65, s31, v129
    v_dot2c_f32_bf16 v69, v129, v129
    v_dot2c_f32_bf16 v66, s31, v130
    v_dot2c_f32_bf16 v70, v130, v130
    v_dot2c_f32_bf16 v67, s31, v131
    v_dot2c_f32_bf16 v71, v131, v131
    v_dot2c_f32_bf16 v64, s31, v132
    v_dot2c_f32_bf16 v68, v132, v132
    v_dot2c_f32_bf16 v65, s31, v133
    v_dot2c_f32_bf16 v69, v133, v133
    v_dot2c_f32_bf16 v66, s31, v134
    v_dot2c_f32_bf16 v70, v134, v134
    v_dot2c_f32_bf16 v67, s31, v135
    v_dot2c_f32_bf16 v71, v135, v135
    v_dot2c_f32_bf16 v64, s31, v136
    v_dot2c_f32_bf16 v68, v136, v136
    v_dot2c_f32_bf16 v65, s31, v137
    v_dot2c_f32_bf16 v69, v137, v137
    v_dot2c_f32_bf16 v66, s31, v138
    v_dot2c_f32_bf16 v70, v138, v138
    v_dot2c_f32_bf16 v67, s31, v139
    v_dot2c_f32_bf16 v71, v139, v139
    v_dot2c_f32_bf16 v64, s31, v140
    v_dot2c_f32_bf16 v68, v140, v140
    v_dot2c_f32_bf16 v65, s31, v141
    v_dot2c_f32_bf16 v69, v141, v141
    v_dot2c_f32_bf16 v66, s31, v142
    v_dot2c_f32_bf16 v70, v142, v142
    v_dot2c_f32_bf16 v67, s31, v143
    v_dot2c_f32_bf16 v71, v143, v143
    s_waitcnt lgkmcnt(12)
    v_mfma_f32_32x32x16_bf16 v[16:31], v[112:115], v[144:147], v[16:31]
    ds_read_b64_tr_b16 v[108:109], v4 offset:6208
    ds_read_b64_tr_b16 v[110:111], v4 offset:6976
    s_waitcnt lgkmcnt(12)
    v_mfma_f32_32x32x16_bf16 v[32:47], v[116:119], v[144:147], v[32:47]
    ds_read_b64_tr_b16 v[112:113], v4 offset:6272
    ds_read_b64_tr_b16 v[114:115], v4 offset:7040
    s_waitcnt lgkmcnt(12)
    v_mfma_f32_32x32x16_bf16 v[48:63], v[120:123], v[144:147], v[48:63]
    ds_read_b64_tr_b16 v[116:117], v4 offset:9216
    ds_read_b64_tr_b16 v[118:119], v4 offset:9984
    s_waitcnt lgkmcnt(12)
    v_mfma_f32_32x32x16_bf16 v[16:31], v[124:127], v[148:151], v[16:31]
    ds_read_b64_tr_b16 v[120:121], v4 offset:9280
    ds_read_b64_tr_b16 v[122:123], v4 offset:10048
    s_waitcnt lgkmcnt(12)
    v_mfma_f32_32x32x16_bf16 v[32:47], v[96:99], v[148:151], v[32:47]
    ds_read_b64_tr_b16 v[124:125], v4 offset:9344
    ds_read_b64_tr_b16 v[126:127], v4 offset:10112
    s_waitcnt lgkmcnt(12)
    v_mfma_f32_32x32x16_bf16 v[48:63], v[100:103], v[148:151], v[48:63]
    s_waitcnt lgkmcnt(10)
    v_mfma_f32_32x32x16_bf16 v[16:31], v[104:107], v[152:155], v[16:31]
    s_waitcnt lgkmcnt(0)
    s_barrier
    v_add_u32 v4, 57344, v92
    v_add_u32 v93, 57344, v88
    ds_read_b128 v[160:163], v93
    v_add_u32 v93, 57344, v89
    ds_read_b128 v[164:167], v93
    v_mfma_f32_32x32x16_bf16 v[32:47], v[108:111], v[152:155], v[32:47]
    v_add_u32 v93, 57344, v90
    ds_read_b128 v[168:171], v93
    v_add_u32 v93, 57344, v91
    ds_read_b128 v[172:175], v93
    v_mfma_f32_32x32x16_bf16 v[48:63], v[112:115], v[152:155], v[48:63]
    ds_read_b64_tr_b16 v[96:97], v4 offset:0
    ds_read_b64_tr_b16 v[98:99], v4 offset:768
    ds_read_b64_tr_b16 v[100:101], v4 offset:64
    ds_read_b64_tr_b16 v[102:103], v4 offset:832
    v_mfma_f32_32x32x16_bf16 v[16:31], v[116:119], v[156:159], v[16:31]
    ds_read_b64_tr_b16 v[104:105], v4 offset:128
    ds_read_b64_tr_b16 v[106:107], v4 offset:896
    ds_read_b64_tr_b16 v[108:109], v4 offset:3072
    ds_read_b64_tr_b16 v[110:111], v4 offset:3840
    v_mfma_f32_32x32x16_bf16 v[32:47], v[120:123], v[156:159], v[32:47]
    ds_read_b64_tr_b16 v[112:113], v4 offset:3136
    ds_read_b64_tr_b16 v[114:115], v4 offset:3904
    ds_read_b64_tr_b16 v[116:117], v4 offset:3200
    ds_read_b64_tr_b16 v[118:119], v4 offset:3968
    v_mfma_f32_32x32x16_bf16 v[48:63], v[124:127], v[156:159], v[48:63]
    ds_read_b64_tr_b16 v[120:121], v4 offset:6144
    ds_read_b64_tr_b16 v[122:123], v4 offset:6912
    v_dot2c_f32_bf16 v64, s31, v144
    v_dot2c_f32_bf16 v68, v144, v144
    v_dot2c_f32_bf16 v65, s31, v145
    v_dot2c_f32_bf16 v69, v145, v145
    v_dot2c_f32_bf16 v66, s31, v146
    v_dot2c_f32_bf16 v70, v146, v146
    v_dot2c_f32_bf16 v67, s31, v147
    v_dot2c_f32_bf16 v71, v147, v147
    v_dot2c_f32_bf16 v64, s31, v148
    v_dot2c_f32_bf16 v68, v148, v148
    v_dot2c_f32_bf16 v65, s31, v149
    v_dot2c_f32_bf16 v69, v149, v149
    v_dot2c_f32_bf16 v66, s31, v150
    v_dot2c_f32_bf16 v70, v150, v150
    v_dot2c_f32_bf16 v67, s31, v151
    v_dot2c_f32_bf16 v71, v151, v151
    v_dot2c_f32_bf16 v64, s31, v152
    v_dot2c_f32_bf16 v68, v152, v152
    v_dot2c_f32_bf16 v65, s31, v153
    v_dot2c_f32_bf16 v69, v153, v153
    v_dot2c_f32_bf16 v66, s31, v154
    v_dot2c_f32_bf16 v70, v154, v154
    v_dot2c_f32_bf16 v67, s31, v155
    v_dot2c_f32_bf16 v71, v155, v155
    v_dot2c_f32_bf16 v64, s31, v156
    v_dot2c_f32_bf16 v68, v156, v156
    v_dot2c_f32_bf16 v65, s31, v157
    v_dot2c_f32_bf16 v69, v157, v157
    v_dot2c_f32_bf16 v66, s31, v158
    v_dot2c_f32_bf16 v70, v158, v158
    v_dot2c_f32_bf16 v67, s31, v159
    v_dot2c_f32_bf16 v71, v159, v159
    s_waitcnt lgkmcnt(12)
    v_mfma_f32_32x32x16_bf16 v[16:31], v[96:99], v[160:163], v[16:31]
    ds_read_b64_tr_b16 v[124:125], v4 offset:6208
    ds_read_b64_tr_b16 v[126:127], v4 offset:6976
    s_waitcnt lgkmcnt(12)
    v_mfma_f32_32x32x16_bf16 v[32:47], v[100:103], v[160:163], v[32:47]
    ds_read_b64_tr_b16 v[96:97], v4 offset:6272
    ds_read_b64_tr_b16 v[98:99], v4 offset:7040
    s_waitcnt lgkmcnt(12)
    v_mfma_f32_32x32x16_bf16 v[48:63], v[104:107], v[160:163], v[48:63]
    ds_read_b64_tr_b16 v[100:101], v4 offset:9216
    ds_read_b64_tr_b16 v[102:103], v4 offset:9984
    s_waitcnt lgkmcnt(12)
    v_mfma_f32_32x32x16_bf16 v[16:31], v[108:111], v[164:167], v[16:31]
    ds_read_b64_tr_b16 v[104:105], v4 offset:9280
    ds_read_b64_tr_b16 v[106:107], v4 offset:10048
    s_waitcnt lgkmcnt(12)
    v_mfma_f32_32x32x16_bf16 v[32:47], v[112:115], v[164:167], v[32:47]
    ds_read_b64_tr_b16 v[108:109], v4 offset:9344
    ds_read_b64_tr_b16 v[110:111], v4 offset:10112
    s_waitcnt lgkmcnt(12)
    v_mfma_f32_32x32x16_bf16 v[48:63], v[116:119], v[164:167], v[48:63]
    s_waitcnt lgkmcnt(10)
    v_mfma_f32_32x32x16_bf16 v[16:31], v[120:123], v[168:171], v[16:31]
    s_waitcnt lgkmcnt(0)
    s_barrier
    v_add_u32 v4, 86016, v92
    v_add_u32 v93, 86016, v88
    ds_read_b128 v[176:179], v93
    v_add_u32 v93, 86016, v89
    ds_read_b128 v[180:183], v93
    v_mfma_f32_32x32x16_bf16 v[32:47], v[124:127], v[168:171], v[32:47]
    v_add_u32 v93, 86016, v90
    ds_read_b128 v[184:187], v93
    v_add_u32 v93, 86016, v91
    ds_read_b128 v[188:191], v93
    v_mfma_f32_32x32x16_bf16 v[48:63], v[96:99], v[168:171], v[48:63]
    ds_read_b64_tr_b16 v[112:113], v4 offset:0
    ds_read_b64_tr_b16 v[114:115], v4 offset:768
    ds_read_b64_tr_b16 v[116:117], v4 offset:64
    ds_read_b64_tr_b16 v[118:119], v4 offset:832
    v_mfma_f32_32x32x16_bf16 v[16:31], v[100:103], v[172:175], v[16:31]
    ds_read_b64_tr_b16 v[120:121], v4 offset:128
    ds_read_b64_tr_b16 v[122:123], v4 offset:896
    ds_read_b64_tr_b16 v[124:125], v4 offset:3072
    ds_read_b64_tr_b16 v[126:127], v4 offset:3840
    v_mfma_f32_32x32x16_bf16 v[32:47], v[104:107], v[172:175], v[32:47]
    ds_read_b64_tr_b16 v[96:97], v4 offset:3136
    ds_read_b64_tr_b16 v[98:99], v4 offset:3904
    ds_read_b64_tr_b16 v[100:101], v4 offset:3200
    ds_read_b64_tr_b16 v[102:103], v4 offset:3968
    v_mfma_f32_32x32x16_bf16 v[48:63], v[108:111], v[172:175], v[48:63]
    ds_read_b64_tr_b16 v[104:105], v4 offset:6144
    ds_read_b64_tr_b16 v[106:107], v4 offset:6912
    v_dot2c_f32_bf16 v64, s31, v160
    v_dot2c_f32_bf16 v68, v160, v160
    v_dot2c_f32_bf16 v65, s31, v161
    v_dot2c_f32_bf16 v69, v161, v161
    v_dot2c_f32_bf16 v66, s31, v162
    v_dot2c_f32_bf16 v70, v162, v162
    v_dot2c_f32_bf16 v67, s31, v163
    v_dot2c_f32_bf16 v71, v163, v163
    v_dot2c_f32_bf16 v64, s31, v164
    v_dot2c_f32_bf16 v68, v164, v164
    v_dot2c_f32_bf16 v65, s31, v165
    v_dot2c_f32_bf16 v69, v165, v165
    v_dot2c_f32_bf16 v66, s31, v166
    v_dot2c_f32_bf16 v70, v166, v166
    v_dot2c_f32_bf16 v67, s31, v167
    v_dot2c_f32_bf16 v71, v167, v167
    v_dot2c_f32_bf16 v64, s31, v168
    v_dot2c_f32_bf16 v68, v168, v168
    v_dot2c_f32_bf16 v65, s31, v169
    v_dot2c_f32_bf16 v69, v169, v169
    v_dot2c_f32_bf16 v66, s31, v170
    v_dot2c_f32_bf16 v70, v170, v170
    v_dot2c_f32_bf16 v67, s31, v171
    v_dot2c_f32_bf16 v71, v171, v171
    v_dot2c_f32_bf16 v64, s31, v172
    v_dot2c_f32_bf16 v68, v172, v172
    v_dot2c_f32_bf16 v65, s31, v173
    v_dot2c_f32_bf16 v69, v173, v173
    v_dot2c_f32_bf16 v66, s31, v174
    v_dot2c_f32_bf16 v70, v174, v174
    v_dot2c_f32_bf16 v67, s31, v175
    v_dot2c_f32_bf16 v71, v175, v175
    s_waitcnt lgkmcnt(12)
    v_mfma_f32_32x32x16_bf16 v[16:31], v[112:115], v[176:179], v[16:31]
    ds_read_b64_tr_b16 v[108:109], v4 offset:6208
    ds_read_b64_tr_b16 v[110:111], v4 offset:6976
    s_waitcnt lgkmcnt(12)
    v_mfma_f32_32x32x16_bf16 v[32:47], v[116:119], v[176:179], v[32:47]
    ds_read_b64_tr_b16 v[112:113], v4 offset:6272
    ds_read_b64_tr_b16 v[114:115], v4 offset:7040
    s_waitcnt lgkmcnt(12)
    v_mfma_f32_32x32x16_bf16 v[48:63], v[120:123], v[176:179], v[48:63]
    ds_read_b64_tr_b16 v[116:117], v4 offset:9216
    ds_read_b64_tr_b16 v[118:119], v4 offset:9984
    s_waitcnt lgkmcnt(12)
    v_mfma_f32_32x32x16_bf16 v[16:31], v[124:127], v[180:183], v[16:31]
    ds_read_b64_tr_b16 v[120:121], v4 offset:9280
    ds_read_b64_tr_b16 v[122:123], v4 offset:10048
    s_waitcnt lgkmcnt(12)
    v_mfma_f32_32x32x16_bf16 v[32:47], v[96:99], v[180:183], v[32:47]
    ds_read_b64_tr_b16 v[124:125], v4 offset:9344
    ds_read_b64_tr_b16 v[126:127], v4 offset:10112
    s_waitcnt lgkmcnt(12)
    v_mfma_f32_32x32x16_bf16 v[48:63], v[100:103], v[180:183], v[48:63]
    s_waitcnt lgkmcnt(10)
    v_mfma_f32_32x32x16_bf16 v[16:31], v[104:107], v[184:187], v[16:31]
    s_waitcnt lgkmcnt(0)
    s_barrier
    v_add_u32 v4, 114688, v92
    v_add_u32 v93, 114688, v88
    ds_read_b128 v[192:195], v93
    v_add_u32 v93, 114688, v89
    ds_read_b128 v[196:199], v93
    v_mfma_f32_32x32x16_bf16 v[32:47], v[108:111], v[184:187], v[32:47]
    v_add_u32 v93, 114688, v90
    ds_read_b128 v[200:203], v93
    v_add_u32 v93, 114688, v91
    ds_read_b128 v[204:207], v93
    v_mfma_f32_32x32x16_bf16 v[48:63], v[112:115], v[184:187], v[48:63]
    ds_read_b64_tr_b16 v[96:97], v4 offset:0
    ds_read_b64_tr_b16 v[98:99], v4 offset:768
    ds_read_b64_tr_b16 v[100:101], v4 offset:64
    ds_read_b64_tr_b16 v[102:103], v4 offset:832
    v_mfma_f32_32x32x16_bf16 v[16:31], v[116:119], v[188:191], v[16:31]
    ds_read_b64_tr_b16 v[104:105], v4 offset:128
    ds_read_b64_tr_b16 v[106:107], v4 offset:896
    ds_read_b64_tr_b16 v[108:109], v4 offset:3072
    ds_read_b64_tr_b16 v[110:111], v4 offset:3840
    v_mfma_f32_32x32x16_bf16 v[32:47], v[120:123], v[188:191], v[32:47]
    ds_read_b64_tr_b16 v[112:113], v4 offset:3136
    ds_read_b64_tr_b16 v[114:115], v4 offset:3904
    ds_read_b64_tr_b16 v[116:117], v4 offset:3200
    ds_read_b64_tr_b16 v[118:119], v4 offset:3968
    v_mfma_f32_32x32x16_bf16 v[48:63], v[124:127], v[188:191], v[48:63]
    ds_read_b64_tr_b16 v[120:121], v4 offset:6144
    ds_read_b64_tr_b16 v[122:123], v4 offset:6912
    v_dot2c_f32_bf16 v64, s31, v176
    v_dot2c_f32_bf16 v68, v176, v176
    v_dot2c_f32_bf16 v65, s31, v177
    v_dot2c_f32_bf16 v69, v177, v177
    v_dot2c_f32_bf16 v66, s31, v178
    v_dot2c_f32_bf16 v70, v178, v178
    v_dot2c_f32_bf16 v67, s31, v179
    v_dot2c_f32_bf16 v71, v179, v179
    v_dot2c_f32_bf16 v64, s31, v180
    v_dot2c_f32_bf16 v68, v180, v180
    v_dot2c_f32_bf16 v65, s31, v181
    v_dot2c_f32_bf16 v69, v181, v181
    v_dot2c_f32_bf16 v66, s31, v182
    v_dot2c_f32_bf16 v70, v182, v182
    v_dot2c_f32_bf16 v67, s31, v183
    v_dot2c_f32_bf16 v71, v183, v183
    v_dot2c_f32_bf16 v64, s31, v184
    v_dot2c_f32_bf16 v68, v184, v184
    v_dot2c_f32_bf16 v65, s31, v185
    v_dot2c_f32_bf16 v69, v185, v185
    v_dot2c_f32_bf16 v66, s31, v186
    v_dot2c_f32_bf16 v70, v186, v186
    v_dot2c_f32_bf16 v67, s31, v187
    v_dot2c_f32_bf16 v71, v187, v187
    v_dot2c_f32_bf16 v64, s31, v188
    v_dot2c_f32_bf16 v68, v188, v188
    v_dot2c_f32_bf16 v65, s31, v189
    v_dot2c_f32_bf16 v69, v189, v189
    v_dot2c_f32_bf16 v66, s31, v190
    v_dot2c_f32_bf16 v70, v190, v190
    v_dot2c_f32_bf16 v67, s31, v191
    v_dot2c_f32_bf16 v71, v191, v191
    v_mov_b32 v13, 0
    global_load_dword v14, v13, s[54:55] sc0 sc1
    s_waitcnt lgkmcnt(12)
    v_mfma_f32_32x32x16_bf16 v[16:31], v[96:99], v[192:195], v[16:31]
    ds_read_b64_tr_b16 v[124:125], v4 offset:6208
    ds_read_b64_tr_b16 v[126:127], v4 offset:6976
    s_waitcnt lgkmcnt(12)
    v_mfma_f32_32x32x16_bf16 v[32:47], v[100:103], v[192:195], v[32:47]
    ds_read_b64_tr_b16 v[96:97], v4 offset:6272
    ds_read_b64_tr_b16 v[98:99], v4 offset:7040
    s_waitcnt lgkmcnt(12)
    v_mfma_f32_32x32x16_bf16 v[48:63], v[104:107], v[192:195], v[48:63]
    ds_read_b64_tr_b16 v[100:101], v4 offset:9216
    ds_read_b64_tr_b16 v[102:103], v4 offset:9984
    s_waitcnt lgkmcnt(12)
    v_mfma_f32_32x32x16_bf16 v[16:31], v[108:111], v[196:199], v[16:31]
    ds_read_b64_tr_b16 v[104:105], v4 offset:9280
    ds_read_b64_tr_b16 v[106:107], v4 offset:10048
    s_waitcnt lgkmcnt(12)
    v_mfma_f32_32x32x16_bf16 v[32:47], v[112:115], v[196:199], v[32:47]
    ds_read_b64_tr_b16 v[108:109], v4 offset:9344
    ds_read_b64_tr_b16 v[110:111], v4 offset:10112
    s_waitcnt lgkmcnt(12)
    v_mfma_f32_32x32x16_bf16 v[48:63], v[116:119], v[196:199], v[48:63]
    s_waitcnt lgkmcnt(10)
    v_mfma_f32_32x32x16_bf16 v[16:31], v[120:123], v[200:203], v[16:31]
    s_waitcnt lgkmcnt(0)
    s_barrier
    v_add_u32 v4, 0, v92
    v_add_u32 v93, 0, v88
    ds_read_b128 v[208:211], v93
    v_add_u32 v93, 0, v89
    ds_read_b128 v[212:215], v93
    v_mfma_f32_32x32x16_bf16 v[32:47], v[124:127], v[200:203], v[32:47]
    v_add_u32 v93, 0, v90
    ds_read_b128 v[216:219], v93
    v_add_u32 v93, 0, v91
    ds_read_b128 v[220:223], v93
    v_mfma_f32_32x32x16_bf16 v[48:63], v[96:99], v[200:203], v[48:63]
    ds_read_b64_tr_b16 v[112:113], v4 offset:0
    ds_read_b64_tr_b16 v[114:115], v4 offset:768
    ds_read_b64_tr_b16 v[116:117], v4 offset:64
    ds_read_b64_tr_b16 v[118:119], v4 offset:832
    v_mfma_f32_32x32x16_bf16 v[16:31], v[100:103], v[204:207], v[16:31]
    ds_read_b64_tr_b16 v[120:121], v4 offset:128
    ds_read_b64_tr_b16 v[122:123], v4 offset:896
    ds_read_b64_tr_b16 v[124:125], v4 offset:3072
    ds_read_b64_tr_b16 v[126:127], v4 offset:3840
    v_mfma_f32_32x32x16_bf16 v[32:47], v[104:107], v[204:207], v[32:47]
    ds_read_b64_tr_b16 v[96:97], v4 offset:3136
    ds_read_b64_tr_b16 v[98:99], v4 offset:3904
    ds_read_b64_tr_b16 v[100:101], v4 offset:3200
    ds_read_b64_tr_b16 v[102:103], v4 offset:3968
    v_mfma_f32_32x32x16_bf16 v[48:63], v[108:111], v[204:207], v[48:63]
    ds_read_b64_tr_b16 v[104:105], v4 offset:6144
    ds_read_b64_tr_b16 v[106:107], v4 offset:6912
    v_dot2c_f32_bf16 v64, s31, v192
    v_dot2c_f32_bf16 v68, v192, v192
    v_dot2c_f32_bf16 v65, s31, v193
    v_dot2c_f32_bf16 v69, v193, v193
    v_dot2c_f32_bf16 v66, s31, v194
    v_dot2c_f32_bf16 v70, v194, v194
    v_dot2c_f32_bf16 v67, s31, v195
    v_dot2c_f32_bf16 v71, v195, v195
    v_dot2c_f32_bf16 v64, s31, v196
    v_dot2c_f32_bf16 v68, v196, v196
    v_dot2c_f32_bf16 v65, s31, v197
    v_dot2c_f32_bf16 v69, v197, v197
    v_dot2c_f32_bf16 v66, s31, v198
    v_dot2c_f32_bf16 v70, v198, v198
    v_dot2c_f32_bf16 v67, s31, v199
    v_dot2c_f32_bf16 v71, v199, v199
    v_dot2c_f32_bf16 v64, s31, v200
    v_dot2c_f32_bf16 v68, v200, v200
    v_dot2c_f32_bf16 v65, s31, v201
    v_dot2c_f32_bf16 v69, v201, v201
    v_dot2c_f32_bf16 v66, s31, v202
    v_dot2c_f32_bf16 v70, v202, v202
    v_dot2c_f32_bf16 v67, s31, v203
    v_dot2c_f32_bf16 v71, v203, v203
    v_dot2c_f32_bf16 v64, s31, v204
    v_dot2c_f32_bf16 v68, v204, v204
    v_dot2c_f32_bf16 v65, s31, v205
    v_dot2c_f32_bf16 v69, v205, v205
    v_dot2c_f32_bf16 v66, s31, v206
    v_dot2c_f32_bf16 v70, v206, v206
    v_dot2c_f32_bf16 v67, s31, v207
    v_dot2c_f32_bf16 v71, v207, v207
    s_waitcnt lgkmcnt(12)
    v_mfma_f32_32x32x16_bf16 v[16:31], v[112:115], v[208:211], v[16:31]
    ds_read_b64_tr_b16 v[108:109], v4 offset:6208
    ds_read_b64_tr_b16 v[110:111], v4 offset:6976
    s_waitcnt lgkmcnt(12)
    v_mfma_f32_32x32x16_bf16 v[32:47], v[116:119], v[208:211], v[32:47]
    ds_read_b64_tr_b16 v[112:113], v4 offset:6272
    ds_read_b64_tr_b16 v[114:115], v4 offset:7040
    s_waitcnt lgkmcnt(12)
    v_mfma_f32_32x32x16_bf16 v[48:63], v[120:123], v[208:211], v[48:63]
    ds_read_b64_tr_b16 v[116:117], v4 offset:9216
    ds_read_b64_tr_b16 v[118:119], v4 offset:9984
    s_waitcnt lgkmcnt(12)
    v_mfma_f32_32x32x16_bf16 v[16:31], v[124:127], v[212:215], v[16:31]
    ds_read_b64_tr_b16 v[120:121], v4 offset:9280
    ds_read_b64_tr_b16 v[122:123], v4 offset:10048
    s_waitcnt lgkmcnt(12)
    v_mfma_f32_32x32x16_bf16 v[32:47], v[96:99], v[212:215], v[32:47]
    ds_read_b64_tr_b16 v[124:125], v4 offset:9344
    ds_read_b64_tr_b16 v[126:127], v4 offset:10112
    s_waitcnt lgkmcnt(12)
    v_mfma_f32_32x32x16_bf16 v[48:63], v[100:103], v[212:215], v[48:63]
    s_waitcnt lgkmcnt(10)
    v_mfma_f32_32x32x16_bf16 v[16:31], v[104:107], v[216:219], v[16:31]
    s_waitcnt lgkmcnt(0)
    s_barrier
    v_add_u32 v4, 28672, v92
    v_add_u32 v93, 28672, v88
    ds_read_b128 v[224:227], v93
    v_add_u32 v93, 28672, v89
    ds_read_b128 v[228:231], v93
    v_mfma_f32_32x32x16_bf16 v[32:47], v[108:111], v[216:219], v[32:47]
    v_add_u32 v93, 28672, v90
    ds_read_b128 v[232:235], v93
    v_add_u32 v93, 28672, v91
    ds_read_b128 v[236:239], v93
    v_mfma_f32_32x32x16_bf16 v[48:63], v[112:115], v[216:219], v[48:63]
    ds_read_b64_tr_b16 v[96:97], v4 offset:0
    ds_read_b64_tr_b16 v[98:99], v4 offset:768
    ds_read_b64_tr_b16 v[100:101], v4 offset:64
    ds_read_b64_tr_b16 v[102:103], v4 offset:832
    v_mfma_f32_32x32x16_bf16 v[16:31], v[116:119], v[220:223], v[16:31]
    ds_read_b64_tr_b16 v[104:105], v4 offset:128
    ds_read_b64_tr_b16 v[106:107], v4 offset:896
    ds_read_b64_tr_b16 v[108:109], v4 offset:3072
    ds_read_b64_tr_b16 v[110:111], v4 offset:3840
    v_mfma_f32_32x32x16_bf16 v[32:47], v[120:123], v[220:223], v[32:47]
    ds_read_b64_tr_b16 v[112:113], v4 offset:3136
    ds_read_b64_tr_b16 v[114:115], v4 offset:3904
    ds_read_b64_tr_b16 v[116:117], v4 offset:3200
    ds_read_b64_tr_b16 v[118:119], v4 offset:3968
    v_mfma_f32_32x32x16_bf16 v[48:63], v[124:127], v[220:223], v[48:63]
    ds_read_b64_tr_b16 v[120:121], v4 offset:6144
    ds_read_b64_tr_b16 v[122:123], v4 offset:6912
    v_dot2c_f32_bf16 v64, s31, v208
    v_dot2c_f32_bf16 v68, v208, v208
    v_dot2c_f32_bf16 v65, s31, v209
    v_dot2c_f32_bf16 v69, v209, v209
    v_dot2c_f32_bf16 v66, s31, v210
    v_dot2c_f32_bf16 v70, v210, v210
    v_dot2c_f32_bf16 v67, s31, v211
    v_dot2c_f32_bf16 v71, v211, v211
    v_dot2c_f32_bf16 v64, s31, v212
    v_dot2c_f32_bf16 v68, v212, v212
    v_dot2c_f32_bf16 v65, s31, v213
    v_dot2c_f32_bf16 v69, v213, v213
    v_dot2c_f32_bf16 v66, s31, v214
    v_dot2c_f32_bf16 v70, v214, v214
    v_dot2c_f32_bf16 v67, s31, v215
    v_dot2c_f32_bf16 v71, v215, v215
    v_dot2c_f32_bf16 v64, s31, v216
    v_dot2c_f32_bf16 v68, v216, v216
    v_dot2c_f32_bf16 v65, s31, v217
    v_dot2c_f32_bf16 v69, v217, v217
    v_dot2c_f32_bf16 v66, s31, v218
    v_dot2c_f32_bf16 v70, v218, v218
    v_dot2c_f32_bf16 v67, s31, v219
    v_dot2c_f32_bf16 v71, v219, v219
    v_dot2c_f32_bf16 v64, s31, v220
    v_dot2c_f32_bf16 v68, v220, v220
    v_dot2c_f32_bf16 v65, s31, v221
    v_dot2c_f32_bf16 v69, v221, v221
    v_dot2c_f32_bf16 v66, s31, v222
    v_dot2c_f32_bf16 v70, v222, v222
    v_dot2c_f32_bf16 v67, s31, v223
    v_dot2c_f32_bf16 v71, v223, v223
    s_waitcnt lgkmcnt(12)
    v_mfma_f32_32x32x16_bf16 v[16:31], v[96:99], v[224:227], v[16:31]
    ds_read_b64_tr_b16 v[124:125], v4 offset:6208
    ds_read_b64_tr_b16 v[126:127], v4 offset:6976
    s_waitcnt lgkmcnt(12)
    v_mfma_f32_32x32x16_bf16 v[32:47], v[100:103], v[224:227], v[32:47]
    ds_read_b64_tr_b16 v[96:97], v4 offset:6272
    ds_read_b64_tr_b16 v[98:99], v4 offset:7040
    s_waitcnt lgkmcnt(12)
    v_mfma_f32_32x32x16_bf16 v[48:63], v[104:107], v[224:227], v[48:63]
    ds_read_b64_tr_b16 v[100:101], v4 offset:9216
    ds_read_b64_tr_b16 v[102:103], v4 offset:9984
    s_waitcnt lgkmcnt(12)
    v_mfma_f32_32x32x16_bf16 v[16:31], v[108:111], v[228:231], v[16:31]
    ds_read_b64_tr_b16 v[104:105], v4 offset:9280
    ds_read_b64_tr_b16 v[106:107], v4 offset:10048
    s_waitcnt lgkmcnt(12)
    v_mfma_f32_32x32x16_bf16 v[32:47], v[112:115], v[228:231], v[32:47]
    ds_read_b64_tr_b16 v[108:109], v4 offset:9344
    ds_read_b64_tr_b16 v[110:111], v4 offset:10112
    s_waitcnt lgkmcnt(12)
    v_mfma_f32_32x32x16_bf16 v[48:63], v[116:119], v[228:231], v[48:63]
    s_waitcnt lgkmcnt(10)
    v_mfma_f32_32x32x16_bf16 v[16:31], v[120:123], v[232:235], v[16:31]
    s_waitcnt lgkmcnt(8)
    v_mfma_f32_32x32x16_bf16 v[32:47], v[124:127], v[232:235], v[32:47]
    s_waitcnt lgkmcnt(6)
    v_mfma_f32_32x32x16_bf16 v[48:63], v[96:99], v[232:235], v[48:63]
    v_dot2c_f32_bf16 v64, s31, v224
    v_dot2c_f32_bf16 v68, v224, v224
    v_dot2c_f32_bf16 v65, s31, v225
    v_dot2c_f32_bf16 v69, v225, v225
    v_dot2c_f32_bf16 v66, s31, v226
    v_dot2c_f32_bf16 v70, v226, v226
    v_dot2c_f32_bf16 v67, s31, v227
    v_dot2c_f32_bf16 v71, v227, v227
    v_dot2c_f32_bf16 v64, s31, v228
    v_dot2c_f32_bf16 v68, v228, v228
    v_dot2c_f32_bf16 v65, s31, v229
    v_dot2c_f32_bf16 v69, v229, v229
    v_dot2c_f32_bf16 v66, s31, v230
    v_dot2c_f32_bf16 v70, v230, v230
    v_dot2c_f32_bf16 v67, s31, v231
    v_dot2c_f32_bf16 v71, v231, v231
    v_dot2c_f32_bf16 v64, s31, v232
    v_dot2c_f32_bf16 v68, v232, v232
    v_dot2c_f32_bf16 v65, s31, v233
    v_dot2c_f32_bf16 v69, v233, v233
    v_dot2c_f32_bf16 v66, s31, v234
    v_dot2c_f32_bf16 v70, v234, v234
    v_dot2c_f32_bf16 v67, s31, v235
    v_dot2c_f32_bf16 v71, v235, v235
    v_dot2c_f32_bf16 v64, s31, v236
    v_dot2c_f32_bf16 v68, v236, v236
    v_dot2c_f32_bf16 v65, s31, v237
    v_dot2c_f32_bf16 v69, v237, v237
    v_dot2c_f32_bf16 v66, s31, v238
    v_dot2c_f32_bf16 v70, v238, v238
    v_dot2c_f32_bf16 v67, s31, v239
    v_dot2c_f32_bf16 v71, v239, v239
    v_add_f32 v64, v64, v65
    v_add_f32 v68, v68, v69
    v_add_f32 v66, v66, v67
    v_add_f32 v70, v70, v71
    v_add_f32 v72, v64, v66
    v_add_f32 v76, v68, v70
    v_mov_b32 v73, v72
    v_mov_b32 v77, v76
    s_nop 0
    v_permlane32_swap_b32 v72, v73
    v_permlane32_swap_b32 v76, v77
    v_add_f32 v72, v72, v73
    v_add_f32 v76, v76, v77
    v_mul_f32 v72, 0x3b124925, v72
    v_mul_f32 v76, 0x3b124925, v76
    v_fma_f32 v76, -v72, v72, v76
    v_cvt_pk_bf16_f32 v73, -v72, -v72
    v_max_f32 v76, 0, v76
    v_and_b32 v74, 0xffff, v73
    v_cvt_pk_bf16_f32 v76, v76, v76
    v_mov_b32 v244, v73
    v_and_b32 v76, 0xffff0000, v76
    v_mov_b32 v245, v74
    v_add_f32 v76, 0x3727c5ac, v76
    v_mov_b32 v246, v73
    v_cvt_pk_bf16_f32 v76, v76, v76
    v_mov_b32 v247, v74
    v_and_b32 v76, 0xffff0000, v76
    v_sqrt_f32 v76, v76
    v_mov_b32 v72, 154624
    v_cvt_pk_bf16_f32 v76, v76, v76
    v_and_b32 v76, 0xffff0000, v76
    v_rcp_f32 v8, v76
    s_waitcnt vmcnt(0)
    v_readfirstlane_b32 s34, v14
    s_nop 1
    s_cmp_lg_u32 s34, 0
    s_cbranch_scc1 K_GEX
    s_mov_b32 s35, 262144
K_GE:
    global_load_dword v14, v13, s[54:55] sc0 sc1
    s_sub_u32 s35, s35, 1
    s_cmp_eq_u32 s35, 0
    s_waitcnt vmcnt(0)
    s_cbranch_scc1 K_GEX
    v_readfirstlane_b32 s34, v14
    s_sleep 4
    s_nop 0
    s_cmp_eq_u32 s34, 0
    s_cbranch_scc1 K_GE
K_GEX:
    ds_write_b32 v72, v14
    s_cmp_ge_u32 s22, 14
    s_cbranch_scc1 K_SHORT
    s_waitcnt lgkmcnt(5)
    v_mfma_f32_32x32x16_bf16 v[16:31], v[100:103], v[236:239], v[16:31]
    s_waitcnt lgkmcnt(0)
    s_barrier
    v_add_u32 v4, 57344, v2
    v_add_u32 v5, 57344, v3
    ds_read_b64_tr_b16 v[112:113], v4 offset:0
    ds_read_b64_tr_b16 v[114:115], v4 offset:512
    ds_read_b64_tr_b16 v[116:117], v5 offset:0
    v_mfma_f32_32x32x16_bf16 v[32:47], v[104:107], v[236:239], v[32:47]
    ds_read_b64_tr_b16 v[118:119], v5 offset:512
    ds_read_b64_tr_b16 v[120:121], v4 offset:2048
    ds_read_b64_tr_b16 v[122:123], v4 offset:2560
    ds_read_b64_tr_b16 v[124:125], v5 offset:2048
    v_mfma_f32_32x32x16_bf16 v[48:63], v[108:111], v[236:239], v[48:63]
    ds_read_b64_tr_b16 v[126:127], v5 offset:2560
    ds_read_b64_tr_b16 v[96:97], v4 offset:4096
    ds_read_b64_tr_b16 v[98:99], v4 offset:4608
    ds_read_b64_tr_b16 v[100:101], v5 offset:4096
    v_add_u32 v10, 32768, v9
    ds_read_b128 v[240:243], v6 offset:0
    ds_read_b128 v[248:251], v6 offset:1024
    ds_read_b128 v[252:255], v6 offset:2048
    s_waitcnt lgkmcnt(2)
    v_mfma_f32_32x32x16_bf16 v[16:31], v[240:243], v[244:247], v[16:31]
    s_waitcnt lgkmcnt(1)
    v_mfma_f32_32x32x16_bf16 v[32:47], v[248:251], v[244:247], v[32:47]
    s_waitcnt lgkmcnt(0)
    v_mfma_f32_32x32x16_bf16 v[48:63], v[252:255], v[244:247], v[48:63]
    s_cmp_lt_u32 s30, 16
    s_cselect_b32 s23, 0x3e8b97f6, 1.0
    v_mul_f32 v7, s23, v8
    s_nop 4
    v_pk_mul_f32 v[16:17], v[16:17], v[6:7] op_sel:[0,1]
    v_cvt_pk_bf16_f32 v16, v16, v17
    v_pk_mul_f32 v[18:19], v[18:19], v[6:7] op_sel:[0,1]
    v_cvt_pk_bf16_f32 v17, v18, v19
    v_pk_mul_f32 v[20:21], v[20:21], v[6:7] op_sel:[0,1]
    v_cvt_pk_bf16_f32 v18, v20, v21
    v_pk_mul_f32 v[22:23], v[22:23], v[6:7] op_sel:[0,1]
    v_cvt_pk_bf16_f32 v19, v22, v23
    ds_write_b128 v9, v[16:19] offset:0
    v_pk_mul_f32 v[24:25], v[24:25], v[6:7] op_sel:[0,1]
    v_cvt_pk_bf16_f32 v20, v24, v25
    v_pk_mul_f32 v[26:27], v[26:27], v[6:7] op_sel:[0,1]
    v_cvt_pk_bf16_f32 v21, v26, v27
    v_pk_mul_f32 v[28:29], v[28:29], v[6:7] op_sel:[0,1]
    v_cvt_pk_bf16_f32 v22, v28, v29
    v_pk_mul_f32 v[30:31], v[30:31], v[6:7] op_sel:[0,1]
    v_cvt_pk_bf16_f32 v23, v30, v31
    ds_write_b128 v9, v[20:23] offset:1024
    s_cmp_lt_u32 s30, 15
    s_cselect_b32 s23, 0x3e8b97f6, 1.0
    v_mul_f32 v7, s23, v8
    v_pk_mul_f32 v[32:33], v[32:33], v[6:7] op_sel:[0,1]
    v_cvt_pk_bf16_f32 v32, v32, v33
    v_pk_mul_f32 v[34:35], v[34:35], v[6:7] op_sel:[0,1]
    v_cvt_pk_bf16_f32 v33, v34, v35
    v_pk_mul_f32 v[36:37], v[36:37], v[6:7] op_sel:[0,1]
    v_cvt_pk_bf16_f32 v34, v36, v37
    v_pk_mul_f32 v[38:39], v[38:39], v[6:7] op_sel:[0,1]
    v_cvt_pk_bf16_f32 v35, v38, v39
    ds_write_b128 v9, v[32:35] offset:8192
    v_pk_mul_f32 v[40:41], v[40:41], v[6:7] op_sel:[0,1]
    v_cvt_pk_bf16_f32 v36, v40, v41
    v_pk_mul_f32 v[42:43], v[42:43], v[6:7] op_sel:[0,1]
    v_cvt_pk_bf16_f32 v37, v42, v43
    v_pk_mul_f32 v[44:45], v[44:45], v[6:7] op_sel:[0,1]
    v_cvt_pk_bf16_f32 v38, v44, v45
    v_pk_mul_f32 v[46:47], v[46:47], v[6:7] op_sel:[0,1]
    v_cvt_pk_bf16_f32 v39, v46, v47
    ds_write_b128 v9, v[36:39] offset:9216
    s_cmp_lt_u32 s30, 14
    s_cselect_b32 s23, 0x3e8b97f6, 1.0
    v_mul_f32 v7, s23, v8
    v_pk_mul_f32 v[48:49], v[48:49], v[6:7] op_sel:[0,1]
    v_cvt_pk_bf16_f32 v48, v48, v49
    v_pk_mul_f32 v[50:51], v[50:51], v[6:7] op_sel:[0,1]
    v_cvt_pk_bf16_f32 v49, v50, v51
    v_pk_mul_f32 v[52:53], v[52:53], v[6:7] op_sel:[0,1]
    v_cvt_pk_bf16_f32 v50, v52, v53
    v_pk_mul_f32 v[54:55], v[54:55], v[6:7] op_sel:[0,1]
    v_cvt_pk_bf16_f32 v51, v54, v55
    ds_write_b128 v9, v[48:51] offset:16384
    v_pk_mul_f32 v[56:57], v[56:57], v[6:7] op_sel:[0,1]
    v_cvt_pk_bf16_f32 v52, v56, v57
    v_pk_mul_f32 v[58:59], v[58:59], v[6:7] op_sel:[0,1]
    v_cvt_pk_bf16_f32 v53, v58, v59
    v_pk_mul_f32 v[60:61], v[60:61], v[6:7] op_sel:[0,1]
    v_cvt_pk_bf16_f32 v54, v60, v61
    v_pk_mul_f32 v[62:63], v[62:63], v[6:7] op_sel:[0,1]
    v_cvt_pk_bf16_f32 v55, v62, v63
    ds_write_b128 v9, v[52:55] offset:17408
    s_waitcnt lgkmcnt(0)
    s_barrier
    v_mfma_f32_32x32x16_bf16 v[64:79], v[112:115], v[128:131], 0
    ds_read_b64_tr_b16 v[102:103], v5 offset:4608
    ds_read_b64_tr_b16 v[104:105], v4 offset:6144
    ds_read_b64_tr_b16 v[106:107], v4 offset:6656
    ds_read_b64_tr_b16 v[108:109], v5 offset:6144
    v_mfma_f32_32x32x16_bf16 v[80:95], v[116:119], v[128:131], 0
    ds_read_b64_tr_b16 v[110:111], v5 offset:6656
    ds_read_b64_tr_b16 v[112:113], v4 offset:8192
    ds_read_b64_tr_b16 v[114:115], v4 offset:8704
    v_mfma_f32_32x32x16_bf16 v[64:79], v[120:123], v[132:135], v[64:79]
    ds_read_b64_tr_b16 v[116:117], v5 offset:8192
    ds_read_b64_tr_b16 v[118:119], v5 offset:8704
    v_mfma_f32_32x32x16_bf16 v[80:95], v[124:127], v[132:135], v[80:95]
    ds_read_b64_tr_b16 v[120:121], v4 offset:10240
    ds_read_b64_tr_b16 v[122:123], v4 offset:10752
    v_mfma_f32_32x32x16_bf16 v[64:79], v[96:99], v[136:139], v[64:79]
    ds_read_b64_tr_b16 v[124:125], v5 offset:10240
    ds_read_b64_tr_b16 v[126:127], v5 offset:10752
    s_waitcnt lgkmcnt(12)
    v_mfma_f32_32x32x16_bf16 v[80:95], v[100:103], v[136:139], v[80:95]
    ds_read_b64_tr_b16 v[96:97], v4 offset:12288
    ds_read_b64_tr_b16 v[98:99], v4 offset:12800
    s_waitcnt lgkmcnt(12)
    v_mfma_f32_32x32x16_bf16 v[64:79], v[104:107], v[140:143], v[64:79]
    ds_read_b64_tr_b16 v[100:101], v5 offset:12288
    ds_read_b64_tr_b16 v[102:103], v5 offset:12800
    s_waitcnt lgkmcnt(12)
    v_mfma_f32_32x32x16_bf16 v[80:95], v[108:111], v[140:143], v[80:95]
    ds_read_b64_tr_b16 v[104:105], v4 offset:14336
    ds_read_b64_tr_b16 v[106:107], v4 offset:14848
    s_waitcnt lgkmcnt(12)
    v_mfma_f32_32x32x16_bf16 v[64:79], v[112:115], v[144:147], v[64:79]
    ds_read_b64_tr_b16 v[108:109], v5 offset:14336
    ds_read_b64_tr_b16 v[110:111], v5 offset:14848
    s_waitcnt lgkmcnt(12)
    v_mfma_f32_32x32x16_bf16 v[80:95], v[116:119], v[144:147], v[80:95]
    ds_read_b64_tr_b16 v[112:113], v4 offset:16384
    ds_read_b64_tr_b16 v[114:115], v4 offset:16896
    s_waitcnt lgkmcnt(12)
    v_mfma_f32_32x32x16_bf16 v[64:79], v[120:123], v[148:151], v[64:79]
    ds_read_b64_tr_b16 v[116:117], v5 offset:16384
    ds_read_b64_tr_b16 v[118:119], v5 offset:16896
    s_waitcnt lgkmcnt(12)
    v_mfma_f32_32x32x16_bf16 v[80:95], v[124:127], v[148:151], v[80:95]
    ds_read_b64_tr_b16 v[120:121], v4 offset:18432
    ds_read_b64_tr_b16 v[122:123], v4 offset:18944
    s_waitcnt lgkmcnt(12)
    v_mfma_f32_32x32x16_bf16 v[64:79], v[96:99], v[152:155], v[64:79]
    ds_read_b64_tr_b16 v[124:125], v5 offset:18432
    ds_read_b64_tr_b16 v[126:127], v5 offset:18944
    s_waitcnt lgkmcnt(12)
    v_mfma_f32_32x32x16_bf16 v[80:95], v[100:103], v[152:155], v[80:95]
    ds_read_b64_tr_b16 v[96:97], v4 offset:20480
    ds_read_b64_tr_b16 v[98:99], v4 offset:20992
    s_waitcnt lgkmcnt(12)
    v_mfma_f32_32x32x16_bf16 v[64:79], v[104:107], v[156:159], v[64:79]
    ds_read_b64_tr_b16 v[100:101], v5 offset:20480
    ds_read_b64_tr_b16 v[102:103], v5 offset:20992
    s_waitcnt lgkmcnt(12)
    v_mfma_f32_32x32x16_bf16 v[80:95], v[108:111], v[156:159], v[80:95]
    ds_read_b64_tr_b16 v[104:105], v4 offset:22528
    ds_read_b64_tr_b16 v[106:107], v4 offset:23040
    s_waitcnt lgkmcnt(12)
    v_mfma_f32_32x32x16_bf16 v[64:79], v[112:115], v[160:163], v[64:79]
    ds_read_b64_tr_b16 v[108:109], v5 offset:22528
    ds_read_b64_tr_b16 v[110:111], v5 offset:23040
    s_waitcnt lgkmcnt(12)
    v_mfma_f32_32x32x16_bf16 v[80:95], v[116:119], v[160:163], v[80:95]
    ds_read_b64_tr_b16 v[112:113], v4 offset:24576
    ds_read_b64_tr_b16 v[114:115], v4 offset:25088
    s_waitcnt lgkmcnt(12)
    v_mfma_f32_32x32x16_bf16 v[64:79], v[120:123], v[164:167], v[64:79]
    ds_read_b64_tr_b16 v[116:117], v5 offset:24576
    ds_read_b64_tr_b16 v[118:119], v5 offset:25088
    s_waitcnt lgkmcnt(12)
    v_mfma_f32_32x32x16_bf16 v[80:95], v[124:127], v[164:167], v[80:95]
    ds_read_b64_tr_b16 v[120:121], v4 offset:26624
    ds_read_b64_tr_b16 v[122:123], v4 offset:27136
    s_waitcnt lgkmcnt(12)
    v_mfma_f32_32x32x16_bf16 v[64:79], v[96:99], v[168:171], v[64:79]
    ds_read_b64_tr_b16 v[124:125], v5 offset:26624
    ds_read_b64_tr_b16 v[126:127], v5 offset:27136
    s_waitcnt lgkmcnt(12)
    v_mfma_f32_32x32x16_bf16 v[80:95], v[100:103], v[168:171], v[80:95]
    v_add_u32 v4, 86016, v2
    v_add_u32 v5, 86016, v3
    ds_read_b64_tr_b16 v[96:97], v4 offset:0
    ds_read_b64_tr_b16 v[98:99], v4 offset:512
    s_waitcnt lgkmcnt(12)
    v_mfma_f32_32x32x16_bf16 v[64:79], v[104:107], v[172:175], v[64:79]
    ds_read_b64_tr_b16 v[100:101], v5 offset:0
    ds_read_b64_tr_b16 v[102:103], v5 offset:512
    s_waitcnt lgkmcnt(12)
    v_mfma_f32_32x32x16_bf16 v[80:95], v[108:111], v[172:175], v[80:95]
    ds_read_b64_tr_b16 v[104:105], v4 offset:2048
    ds_read_b64_tr_b16 v[106:107], v4 offset:2560
    s_waitcnt lgkmcnt(12)
    v_mfma_f32_32x32x16_bf16 v[64:79], v[112:115], v[176:179], v[64:79]
    ds_read_b64_tr_b16 v[108:109], v5 offset:2048
    ds_read_b64_tr_b16 v[110:111], v5 offset:2560
    s_waitcnt lgkmcnt(12)
    v_mfma_f32_32x32x16_bf16 v[80:95], v[116:119], v[176:179], v[80:95]
    ds_read_b64_tr_b16 v[112:113], v4 offset:4096
    ds_read_b64_tr_b16 v[114:115], v4 offset:4608
    s_waitcnt lgkmcnt(12)
    v_mfma_f32_32x32x16_bf16 v[64:79], v[120:123], v[180:183], v[64:79]
    ds_read_b64_tr_b16 v[116:117], v5 offset:4096
    ds_read_b64_tr_b16 v[118:119], v5 offset:4608
    s_waitcnt lgkmcnt(12)
    v_mfma_f32_32x32x16_bf16 v[80:95], v[124:127], v[180:183], v[80:95]
    ds_read_b64_tr_b16 v[120:121], v4 offset:6144
    ds_read_b64_tr_b16 v[122:123], v4 offset:6656
    s_waitcnt lgkmcnt(12)
    v_mfma_f32_32x32x16_bf16 v[64:79], v[96:99], v[184:187], v[64:79]
    ds_read_b64_tr_b16 v[124:125], v5 offset:6144
    ds_read_b64_tr_b16 v[126:127], v5 offset:6656
    s_waitcnt lgkmcnt(12)
    v_mfma_f32_32x32x16_bf16 v[80:95], v[100:103], v[184:187], v[80:95]
    ds_read_b64_tr_b16 v[96:97], v4 offset:8192
    ds_read_b64_tr_b16 v[98:99], v4 offset:8704
    s_waitcnt lgkmcnt(12)
    v_mfma_f32_32x32x16_bf16 v[64:79], v[104:107], v[188:191], v[64:79]
    ds_read_b64_tr_b16 v[100:101], v5 offset:8192
    ds_read_b64_tr_b16 v[102:103], v5 offset:8704
    s_waitcnt lgkmcnt(12)
    v_mfma_f32_32x32x16_bf16 v[80:95], v[108:111], v[188:191], v[80:95]
    ds_read_b64_tr_b16 v[104:105], v4 offset:10240
    ds_read_b64_tr_b16 v[106:107], v4 offset:10752
    s_waitcnt lgkmcnt(12)
    v_mfma_f32_32x32x16_bf16 v[64:79], v[112:115], v[192:195], v[64:79]
    ds_read_b64_tr_b16 v[108:109], v5 offset:10240
    ds_read_b64_tr_b16 v[110:111], v5 offset:10752
    s_waitcnt lgkmcnt(12)
    v_mfma_f32_32x32x16_bf16 v[80:95], v[116:119], v[192:195], v[80:95]
    ds_read_b64_tr_b16 v[112:113], v4 offset:12288
    ds_read_b64_tr_b16 v[114:115], v4 offset:12800
    s_waitcnt lgkmcnt(12)
    v_mfma_f32_32x32x16_bf16 v[64:79], v[120:123], v[196:199], v[64:79]
    ds_read_b64_tr_b16 v[116:117], v5 offset:12288
    ds_read_b64_tr_b16 v[118:119], v5 offset:12800
    s_waitcnt lgkmcnt(12)
    v_mfma_f32_32x32x16_bf16 v[80:95], v[124:127], v[196:199], v[80:95]
    ds_read_b64_tr_b16 v[120:121], v4 offset:14336
    ds_read_b64_tr_b16 v[122:123], v4 offset:14848
    s_waitcnt lgkmcnt(12)
    v_mfma_f32_32x32x16_bf16 v[64:79], v[96:99], v[200:203], v[64:79]
    ds_read_b64_tr_b16 v[124:125], v5 offset:14336
    ds_read_b64_tr_b16 v[126:127], v5 offset:14848
    s_waitcnt lgkmcnt(12)
    v_mfma_f32_32x32x16_bf16 v[80:95], v[100:103], v[200:203], v[80:95]
    ds_read_b64_tr_b16 v[96:97], v4 offset:16384
    ds_read_b64_tr_b16 v[98:99], v4 offset:16896
    s_waitcnt lgkmcnt(12)
    v_mfma_f32_32x32x16_bf16 v[64:79], v[104:107], v[204:207], v[64:79]
    ds_read_b64_tr_b16 v[100:101], v5 offset:16384
    ds_read_b64_tr_b16 v[102:103], v5 offset:16896
    s_waitcnt lgkmcnt(12)
    v_mfma_f32_32x32x16_bf16 v[80:95], v[108:111], v[204:207], v[80:95]
    ds_read_b64_tr_b16 v[104:105], v4 offset:18432
    ds_read_b64_tr_b16 v[106:107], v4 offset:18944
    s_waitcnt lgkmcnt(12)
    v_mfma_f32_32x32x16_bf16 v[64:79], v[112:115], v[208:211], v[64:79]
    ds_read_b64_tr_b16 v[108:109], v5 offset:18432
    ds_read_b64_tr_b16 v[110:111], v5 offset:18944
    s_waitcnt lgkmcnt(12)
    v_mfma_f32_32x32x16_bf16 v[80:95], v[116:119], v[208:211], v[80:95]
    ds_read_b64_tr_b16 v[112:113], v4 offset:20480
    ds_read_b64_tr_b16 v[114:115], v4 offset:20992
    s_waitcnt lgkmcnt(12)
    v_mfma_f32_32x32x16_bf16 v[64:79], v[120:123], v[212:215], v[64:79]
    ds_read_b64_tr_b16 v[116:117], v5 offset:20480
    ds_read_b64_tr_b16 v[118:119], v5 offset:20992
    s_waitcnt lgkmcnt(12)
    v_mfma_f32_32x32x16_bf16 v[80:95], v[124:127], v[212:215], v[80:95]
    ds_read_b64_tr_b16 v[120:121], v4 offset:22528
    ds_read_b64_tr_b16 v[122:123], v4 offset:23040
    s_waitcnt lgkmcnt(12)
    v_mfma_f32_32x32x16_bf16 v[64:79], v[96:99], v[216:219], v[64:79]
    ds_read_b64_tr_b16 v[124:125], v5 offset:22528
    ds_read_b64_tr_b16 v[126:127], v5 offset:23040
    s_waitcnt lgkmcnt(12)
    v_mfma_f32_32x32x16_bf16 v[80:95], v[100:103], v[216:219], v[80:95]
    ds_read_b64_tr_b16 v[96:97], v4 offset:24576
    ds_read_b64_tr_b16 v[98:99], v4 offset:25088
    s_waitcnt lgkmcnt(12)
    v_mfma_f32_32x32x16_bf16 v[64:79], v[104:107], v[220:223], v[64:79]
    ds_read_b64_tr_b16 v[100:101], v5 offset:24576
    ds_read_b64_tr_b16 v[102:103], v5 offset:25088
    s_waitcnt lgkmcnt(12)
    v_mfma_f32_32x32x16_bf16 v[80:95], v[108:111], v[220:223], v[80:95]
    ds_read_b64_tr_b16 v[104:105], v4 offset:26624
    ds_read_b64_tr_b16 v[106:107], v4 offset:27136
    s_waitcnt lgkmcnt(12)
    v_mfma_f32_32x32x16_bf16 v[64:79], v[112:115], v[224:227], v[64:79]
    ds_read_b64_tr_b16 v[108:109], v5 offset:26624
    ds_read_b64_tr_b16 v[110:111], v5 offset:27136
    s_waitcnt lgkmcnt(12)
    v_mfma_f32_32x32x16_bf16 v[80:95], v[116:119], v[224:227], v[80:95]
    v_add_u32 v4, 114688, v2
    v_add_u32 v5, 114688, v3
    ds_read_b64_tr_b16 v[112:113], v4 offset:0
    ds_read_b64_tr_b16 v[114:115], v4 offset:512
    s_waitcnt lgkmcnt(12)
    v_mfma_f32_32x32x16_bf16 v[64:79], v[120:123], v[228:231], v[64:79]
    ds_read_b64_tr_b16 v[116:117], v5 offset:0
    ds_read_b64_tr_b16 v[118:119], v5 offset:512
    s_waitcnt lgkmcnt(12)
    v_mfma_f32_32x32x16_bf16 v[80:95], v[124:127], v[228:231], v[80:95]
    ds_read_b64_tr_b16 v[120:121], v4 offset:2048
    ds_read_b64_tr_b16 v[122:123], v4 offset:2560
    s_waitcnt lgkmcnt(12)
    v_mfma_f32_32x32x16_bf16 v[64:79], v[96:99], v[232:235], v[64:79]
    ds_read_b64_tr_b16 v[124:125], v5 offset:2048
    ds_read_b64_tr_b16 v[126:127], v5 offset:2560
    s_waitcnt lgkmcnt(12)
    v_mfma_f32_32x32x16_bf16 v[80:95], v[100:103], v[232:235], v[80:95]
    ds_read_b64_tr_b16 v[96:97], v4 offset:4096
    ds_read_b64_tr_b16 v[98:99], v4 offset:4608
    s_waitcnt lgkmcnt(12)
    v_mfma_f32_32x32x16_bf16 v[64:79], v[104:107], v[236:239], v[64:79]
    ds_read_b64_tr_b16 v[100:101], v5 offset:4096
    ds_read_b64_tr_b16 v[102:103], v5 offset:4608
    s_waitcnt lgkmcnt(12)
    v_mfma_f32_32x32x16_bf16 v[80:95], v[108:111], v[236:239], v[80:95]
    ds_read_b64_tr_b16 v[104:105], v4 offset:6144
    ds_read_b64_tr_b16 v[106:107], v4 offset:6656
    s_waitcnt lgkmcnt(12)
    v_mfma_f32_32x32x16_bf16 v[16:31], v[112:115], v[128:131], 0
    ds_read_b64_tr_b16 v[108:109], v5 offset:6144
    ds_read_b64_tr_b16 v[110:111], v5 offset:6656
    s_barrier
    s_waitcnt lgkmcnt(12)
    v_mfma_f32_32x32x16_bf16 v[32:47], v[116:119], v[128:131], 0
    ds_read_b64_tr_b16 v[112:113], v4 offset:8192
    ds_read_b64_tr_b16 v[114:115], v4 offset:8704
    ds_read_b128 v[240:243], v6 offset:3072
    ds_read_b128 v[248:251], v6 offset:4096
    s_waitcnt lgkmcnt(14)
    v_mfma_f32_32x32x16_bf16 v[16:31], v[120:123], v[132:135], v[16:31]
    ds_read_b64_tr_b16 v[116:117], v5 offset:8192
    ds_read_b64_tr_b16 v[118:119], v5 offset:8704
    s_waitcnt lgkmcnt(14)
    v_mfma_f32_32x32x16_bf16 v[32:47], v[124:127], v[132:135], v[32:47]
    ds_read_b64_tr_b16 v[120:121], v4 offset:10240
    ds_read_b64_tr_b16 v[122:123], v4 offset:10752
    s_waitcnt lgkmcnt(5)
    v_mfma_f32_32x32x16_bf16 v[64:79], v[240:243], v[244:247], v[64:79]
    v_mfma_f32_32x32x16_bf16 v[16:31], v[96:99], v[136:139], v[16:31]
    ds_read_b64_tr_b16 v[124:125], v5 offset:10240
    ds_read_b64_tr_b16 v[126:127], v5 offset:10752
    s_waitcnt lgkmcnt(6)
    v_mfma_f32_32x32x16_bf16 v[80:95], v[248:251], v[244:247], v[80:95]
    v_mfma_f32_32x32x16_bf16 v[32:47], v[100:103], v[136:139], v[32:47]
    ds_read_b64_tr_b16 v[96:97], v4 offset:12288
    ds_read_b64_tr_b16 v[98:99], v4 offset:12800
    s_nop 3
    v_mul_f32 v64, v8, v64
    v_mul_f32 v65, v8, v65
    v_mfma_f32_32x32x16_bf16 v[16:31], v[104:107], v[140:143], v[16:31]
    ds_read_b64_tr_b16 v[100:101], v5 offset:12288
    ds_read_b64_tr_b16 v[102:103], v5 offset:12800
    v_cvt_pk_bf16_f32 v64, v64, v65
    v_mul_f32 v66, v8, v66
    v_mfma_f32_32x32x16_bf16 v[32:47], v[108:111], v[140:143], v[32:47]
    ds_read_b64_tr_b16 v[104:105], v4 offset:14336
    ds_read_b64_tr_b16 v[106:107], v4 offset:14848
    v_mul_f32 v67, v8, v67
    v_cvt_pk_bf16_f32 v65, v66, v67
    v_mfma_f32_32x32x16_bf16 v[16:31], v[112:115], v[144:147], v[16:31]
    ds_read_b64_tr_b16 v[108:109], v5 offset:14336
    ds_read_b64_tr_b16 v[110:111], v5 offset:14848
    v_mul_f32 v68, v8, v68
    v_mul_f32 v69, v8, v69
    s_waitcnt lgkmcnt(12)
    v_mfma_f32_32x32x16_bf16 v[32:47], v[116:119], v[144:147], v[32:47]
    ds_read_b64_tr_b16 v[112:113], v4 offset:16384
    ds_read_b64_tr_b16 v[114:115], v4 offset:16896
    v_cvt_pk_bf16_f32 v66, v68, v69
    v_mul_f32 v70, v8, v70
    s_waitcnt lgkmcnt(12)
    v_mfma_f32_32x32x16_bf16 v[16:31], v[120:123], v[148:151], v[16:31]
    ds_read_b64_tr_b16 v[116:117], v5 offset:16384
    ds_read_b64_tr_b16 v[118:119], v5 offset:16896
    v_mul_f32 v71, v8, v71
    v_cvt_pk_bf16_f32 v67, v70, v71
    s_waitcnt lgkmcnt(12)
    v_mfma_f32_32x32x16_bf16 v[32:47], v[124:127], v[148:151], v[32:47]
    ds_read_b64_tr_b16 v[120:121], v4 offset:18432
    ds_read_b64_tr_b16 v[122:123], v4 offset:18944
    ds_write_b128 v9, v[64:67] offset:28672
    v_mul_f32 v72, v8, v72
    s_waitcnt lgkmcnt(13)
    v_mfma_f32_32x32x16_bf16 v[16:31], v[96:99], v[152:155], v[16:31]
    ds_read_b64_tr_b16 v[124:125], v5 offset:18432
    ds_read_b64_tr_b16 v[126:127], v5 offset:18944
    v_mul_f32 v73, v8, v73
    v_cvt_pk_bf16_f32 v68, v72, v73
    s_waitcnt lgkmcnt(13)
    v_mfma_f32_32x32x16_bf16 v[32:47], v[100:103], v[152:155], v[32:47]
    ds_read_b64_tr_b16 v[96:97], v4 offset:20480
    ds_read_b64_tr_b16 v[98:99], v4 offset:20992
    v_mul_f32 v74, v8, v74
    v_mul_f32 v75, v8, v75
    s_waitcnt lgkmcnt(13)
    v_mfma_f32_32x32x16_bf16 v[16:31], v[104:107], v[156:159], v[16:31]
    ds_read_b64_tr_b16 v[100:101], v5 offset:20480
    ds_read_b64_tr_b16 v[102:103], v5 offset:20992
    v_cvt_pk_bf16_f32 v69, v74, v75
    v_mul_f32 v76, v8, v76
    s_waitcnt lgkmcnt(13)
    v_mfma_f32_32x32x16_bf16 v[32:47], v[108:111], v[156:159], v[32:47]
    ds_read_b64_tr_b16 v[104:105], v4 offset:22528
    ds_read_b64_tr_b16 v[106:107], v4 offset:23040
    v_mul_f32 v77, v8, v77
    v_cvt_pk_bf16_f32 v70, v76, v77
    s_waitcnt lgkmcnt(13)
    v_mfma_f32_32x32x16_bf16 v[16:31], v[112:115], v[160:163], v[16:31]
    ds_read_b64_tr_b16 v[108:109], v5 offset:22528
    ds_read_b64_tr_b16 v[110:111], v5 offset:23040
    v_mul_f32 v78, v8, v78
    v_mul_f32 v79, v8, v79
    s_waitcnt lgkmcnt(13)
    v_mfma_f32_32x32x16_bf16 v[32:47], v[116:119], v[160:163], v[32:47]
    ds_read_b64_tr_b16 v[112:113], v4 offset:24576
    ds_read_b64_tr_b16 v[114:115], v4 offset:25088
    v_cvt_pk_bf16_f32 v71, v78, v79
    ds_write_b128 v9, v[68:71] offset:29696
    s_waitcnt lgkmcnt(14)
    v_mfma_f32_32x32x16_bf16 v[16:31], v[120:123], v[164:167], v[16:31]
    ds_read_b64_tr_b16 v[116:117], v5 offset:24576
    ds_read_b64_tr_b16 v[118:119], v5 offset:25088
    v_mul_f32 v80, v8, v80
    v_mul_f32 v81, v8, v81
    s_waitcnt lgkmcnt(13)
    v_mfma_f32_32x32x16_bf16 v[32:47], v[124:127], v[164:167], v[32:47]
    ds_read_b64_tr_b16 v[120:121], v4 offset:26624
    ds_read_b64_tr_b16 v[122:123], v4 offset:27136
    v_cvt_pk_bf16_f32 v80, v80, v81
    v_mul_f32 v82, v8, v82
    s_waitcnt lgkmcnt(13)
    v_mfma_f32_32x32x16_bf16 v[16:31], v[96:99], v[168:171], v[16:31]
    ds_read_b64_tr_b16 v[124:125], v5 offset:26624
    ds_read_b64_tr_b16 v[126:127], v5 offset:27136
    v_mul_f32 v83, v8, v83
    v_cvt_pk_bf16_f32 v81, v82, v83
    s_waitcnt lgkmcnt(13)
    v_mfma_f32_32x32x16_bf16 v[32:47], v[100:103], v[168:171], v[32:47]
    v_add_u32 v4, 0, v2
    v_add_u32 v5, 0, v3
    ds_read_b64_tr_b16 v[96:97], v4 offset:0
    ds_read_b64_tr_b16 v[98:99], v4 offset:512
    v_mul_f32 v84, v8, v84
    v_mul_f32 v85, v8, v85
    s_waitcnt lgkmcnt(13)
    v_mfma_f32_32x32x16_bf16 v[16:31], v[104:107], v[172:175], v[16:31]
    ds_read_b64_tr_b16 v[100:101], v5 offset:0
    ds_read_b64_tr_b16 v[102:103], v5 offset:512
    v_cvt_pk_bf16_f32 v82, v84, v85
    v_mul_f32 v86, v8, v86
    s_waitcnt lgkmcnt(13)
    v_mfma_f32_32x32x16_bf16 v[32:47], v[108:111], v[172:175], v[32:47]
    ds_read_b64_tr_b16 v[104:105], v4 offset:2048
    ds_read_b64_tr_b16 v[106:107], v4 offset:2560
    v_mul_f32 v87, v8, v87
    v_cvt_pk_bf16_f32 v83, v86, v87
    s_waitcnt lgkmcnt(13)
    v_mfma_f32_32x32x16_bf16 v[16:31], v[112:115], v[176:179], v[16:31]
    ds_read_b64_tr_b16 v[108:109], v5 offset:2048
    ds_read_b64_tr_b16 v[110:111], v5 offset:2560
    ds_write_b128 v9, v[80:83] offset:36864
    v_mul_f32 v88, v8, v88
    s_waitcnt lgkmcnt(13)
    v_mfma_f32_32x32x16_bf16 v[32:47], v[116:119], v[176:179], v[32:47]
    ds_read_b64_tr_b16 v[112:113], v4 offset:4096
    ds_read_b64_tr_b16 v[114:115], v4 offset:4608
    v_mul_f32 v89, v8, v89
    v_cvt_pk_bf16_f32 v84, v88, v89
    s_waitcnt lgkmcnt(13)
    v_mfma_f32_32x32x16_bf16 v[16:31], v[120:123], v[180:183], v[16:31]
    ds_read_b64_tr_b16 v[116:117], v5 offset:4096
    ds_read_b64_tr_b16 v[118:119], v5 offset:4608
    v_mul_f32 v90, v8, v90
    v_mul_f32 v91, v8, v91
    s_waitcnt lgkmcnt(13)
    v_mfma_f32_32x32x16_bf16 v[32:47], v[124:127], v[180:183], v[32:47]
    ds_read_b64_tr_b16 v[120:121], v4 offset:6144
    ds_read_b64_tr_b16 v[122:123], v4 offset:6656
    v_cvt_pk_bf16_f32 v85, v90, v91
    v_mul_f32 v92, v8, v92
    s_waitcnt lgkmcnt(13)
    v_mfma_f32_32x32x16_bf16 v[16:31], v[96:99], v[184:187], v[16:31]
    ds_read_b64_tr_b16 v[124:125], v5 offset:6144
    ds_read_b64_tr_b16 v[126:127], v5 offset:6656
    v_mul_f32 v93, v8, v93
    v_cvt_pk_bf16_f32 v86, v92, v93
    s_waitcnt lgkmcnt(13)
    v_mfma_f32_32x32x16_bf16 v[32:47], v[100:103], v[184:187], v[32:47]
    ds_read_b64_tr_b16 v[96:97], v4 offset:8192
    ds_read_b64_tr_b16 v[98:99], v4 offset:8704
    v_mul_f32 v94, v8, v94
    v_mul_f32 v95, v8, v95
    s_waitcnt lgkmcnt(13)
    v_mfma_f32_32x32x16_bf16 v[16:31], v[104:107], v[188:191], v[16:31]
    ds_read_b64_tr_b16 v[100:101], v5 offset:8192
    ds_read_b64_tr_b16 v[102:103], v5 offset:8704
    v_cvt_pk_bf16_f32 v87, v94, v95
    ds_write_b128 v9, v[84:87] offset:37888
    buffer_load_dword v14, v15, s[16:19], 0 offen sc1
    s_waitcnt lgkmcnt(14)
    v_mfma_f32_32x32x16_bf16 v[32:47], v[108:111], v[188:191], v[32:47]
    ds_read_b64_tr_b16 v[104:105], v4 offset:10240
    ds_read_b64_tr_b16 v[106:107], v4 offset:10752
    s_waitcnt lgkmcnt(13)
    v_mfma_f32_32x32x16_bf16 v[16:31], v[112:115], v[192:195], v[16:31]
    ds_read_b64_tr_b16 v[108:109], v5 offset:10240
    ds_read_b64_tr_b16 v[110:111], v5 offset:10752
    s_waitcnt lgkmcnt(13)
    v_mfma_f32_32x32x16_bf16 v[32:47], v[116:119], v[192:195], v[32:47]
    ds_read_b64_tr_b16 v[112:113], v4 offset:12288
    ds_read_b64_tr_b16 v[114:115], v4 offset:12800
    s_waitcnt lgkmcnt(6)
    s_barrier
    v_mfma_f32_32x32x16_bf16 v[16:31], v[120:123], v[196:199], v[16:31]
    ds_read_b64_tr_b16 v[116:117], v5 offset:12288
    ds_read_b64_tr_b16 v[118:119], v5 offset:12800
    v_mfma_f32_32x32x16_bf16 v[32:47], v[124:127], v[196:199], v[32:47]
    ds_read_b64_tr_b16 v[120:121], v4 offset:14336
    ds_read_b64_tr_b16 v[122:123], v4 offset:14848
    v_mfma_f32_32x32x16_bf16 v[16:31], v[96:99], v[200:203], v[16:31]
    ds_read_b64_tr_b16 v[124:125], v5 offset:14336
    ds_read_b64_tr_b16 v[126:127], v5 offset:14848
    v_mfma_f32_32x32x16_bf16 v[32:47], v[100:103], v[200:203], v[32:47]
    ds_read_b64_tr_b16 v[96:97], v4 offset:16384
    ds_read_b64_tr_b16 v[98:99], v4 offset:16896
    s_waitcnt lgkmcnt(12)
    v_mfma_f32_32x32x16_bf16 v[16:31], v[104:107], v[204:207], v[16:31]
    ds_read_b64_tr_b16 v[100:101], v5 offset:16384
    ds_read_b64_tr_b16 v[102:103], v5 offset:16896
    s_waitcnt lgkmcnt(12)
    v_mfma_f32_32x32x16_bf16 v[32:47], v[108:111], v[204:207], v[32:47]
    ds_read_b64_tr_b16 v[104:105], v4 offset:18432
    ds_read_b64_tr_b16 v[106:107], v4 offset:18944
    s_waitcnt lgkmcnt(12)
    v_mfma_f32_32x32x16_bf16 v[16:31], v[112:115], v[208:211], v[16:31]
    ds_read_b64_tr_b16 v[108:109], v5 offset:18432
    ds_read_b64_tr_b16 v[110:111], v5 offset:18944
    s_waitcnt lgkmcnt(12)
    v_mfma_f32_32x32x16_bf16 v[32:47], v[116:119], v[208:211], v[32:47]
    ds_read_b64_tr_b16 v[112:113], v4 offset:20480
    ds_read_b64_tr_b16 v[114:115], v4 offset:20992
    s_waitcnt lgkmcnt(12)
    v_mfma_f32_32x32x16_bf16 v[16:31], v[120:123], v[212:215], v[16:31]
    ds_read_b64_tr_b16 v[116:117], v5 offset:20480
    ds_read_b64_tr_b16 v[118:119], v5 offset:20992
    s_waitcnt vmcnt(0)
    v_cmp_ne_u32 vcc, s34, v14
    s_nop 1
    s_cbranch_vccz K_PQ1X
    s_mov_b32 s35, 262144
K_PQ1:
    s_sleep 12
    buffer_load_dword v14, v15, s[16:19], 0 offen sc1
    s_sub_u32 s35, s35, 1
    s_cmp_eq_u32 s35, 0
    s_waitcnt vmcnt(0)
    s_cbranch_scc1 K_PQ1X
    v_cmp_ne_u32 vcc, s34, v14
    s_nop 1
    s_cbranch_vccnz K_PQ1
K_PQ1X:
    s_lshl_b32 s33, s38, 18
    s_add_u32 s33, s33, 2097152
    buffer_load_dwordx4 v[48:51], v1, s[16:19], s33 offen sc1
    s_waitcnt lgkmcnt(12)
    v_mfma_f32_32x32x16_bf16 v[32:47], v[124:127], v[212:215], v[32:47]
    ds_read_b64_tr_b16 v[120:121], v4 offset:22528
    ds_read_b64_tr_b16 v[122:123], v4 offset:23040
    buffer_load_dwordx4 v[52:55], v1, s[16:19], s33 offen offset:1024 sc1
    s_lshl_b32 s23, s38, 6
    s_lshl_b32 s24, s39, 2
    s_waitcnt lgkmcnt(12)
    v_mfma_f32_32x32x16_bf16 v[16:31], v[96:99], v[216:219], v[16:31]
    ds_read_b64_tr_b16 v[124:125], v5 offset:22528
    ds_read_b64_tr_b16 v[126:127], v5 offset:23040
    s_add_u32 s23, s23, s24
    s_xor_b32 s24, s20, 1
    s_add_u32 s24, s24, s23
    s_waitcnt lgkmcnt(12)
    v_mfma_f32_32x32x16_bf16 v[32:47], v[100:103], v[216:219], v[32:47]
    ds_read_b64_tr_b16 v[96:97], v4 offset:24576
    ds_read_b64_tr_b16 v[98:99], v4 offset:25088
    s_lshl_b32 s24, s24, 11
    buffer_load_dwordx4 v[128:131], v1, s[16:19], s24 offen sc1
    buffer_load_dwordx4 v[132:135], v1, s[16:19], s24 offen offset:1024 sc1
    s_waitcnt lgkmcnt(12)
    v_mfma_f32_32x32x16_bf16 v[16:31], v[104:107], v[220:223], v[16:31]
    ds_read_b64_tr_b16 v[100:101], v5 offset:24576
    ds_read_b64_tr_b16 v[102:103], v5 offset:25088
    s_xor_b32 s24, s20, 2
    s_add_u32 s24, s24, s23
    s_waitcnt lgkmcnt(12)
    v_mfma_f32_32x32x16_bf16 v[32:47], v[108:111], v[220:223], v[32:47]
    ds_read_b64_tr_b16 v[104:105], v4 offset:26624
    ds_read_b64_tr_b16 v[106:107], v4 offset:27136
    s_lshl_b32 s24, s24, 11
    buffer_load_dwordx4 v[136:139], v1, s[16:19], s24 offen sc1
    buffer_load_dwordx4 v[140:143], v1, s[16:19], s24 offen offset:1024 sc1
    s_waitcnt lgkmcnt(12)
    v_mfma_f32_32x32x16_bf16 v[16:31], v[112:115], v[224:227], v[16:31]
    ds_read_b64_tr_b16 v[108:109], v5 offset:26624
    ds_read_b64_tr_b16 v[110:111], v5 offset:27136
    s_xor_b32 s24, s20, 3
    s_add_u32 s24, s24, s23
    s_lshl_b32 s24, s24, 11
    s_waitcnt lgkmcnt(12)
    v_mfma_f32_32x32x16_bf16 v[32:47], v[116:119], v[224:227], v[32:47]
    buffer_load_dwordx4 v[144:147], v1, s[16:19], s24 offen sc1
    buffer_load_dwordx4 v[148:151], v1, s[16:19], s24 offen offset:1024 sc1
    s_xor_b32 s24, s20, 0
    s_waitcnt lgkmcnt(10)
    v_mfma_f32_32x32x16_bf16 v[16:31], v[120:123], v[228:231], v[16:31]
    s_add_u32 s24, s24, s23
    s_lshl_b32 s24, s24, 11
    s_waitcnt lgkmcnt(8)
    v_mfma_f32_32x32x16_bf16 v[32:47], v[124:127], v[228:231], v[32:47]
    buffer_load_dwordx4 v[152:155], v1, s[16:19], s24 offen sc1
    buffer_load_dwordx4 v[156:159], v1, s[16:19], s24 offen offset:1024 sc1
    s_lshl_b32 s23, s20, 16
    s_waitcnt lgkmcnt(6)
    v_mfma_f32_32x32x16_bf16 v[16:31], v[96:99], v[232:235], v[16:31]
    s_add_u32 s29, s33, s23
    s_add_u32 s32, s29, 4096
    buffer_load_dwordx4 v[160:163], v1, s[16:19], s29 offen offset:0 sc1
    ds_read_b128 v[252:255], v6 offset:5120
    ds_read_b128 v[240:243], v6 offset:6144
    s_waitcnt lgkmcnt(6)
    v_mfma_f32_32x32x16_bf16 v[32:47], v[100:103], v[232:235], v[32:47]
    buffer_load_dwordx4 v[164:167], v1, s[16:19], s29 offen offset:1024 sc1
    buffer_load_dwordx4 v[168:171], v1, s[16:19], s29 offen offset:2048 sc1
    buffer_load_dwordx4 v[172:175], v1, s[16:19], s29 offen offset:3072 sc1
    s_waitcnt lgkmcnt(4)
    v_mfma_f32_32x32x16_bf16 v[16:31], v[104:107], v[236:239], v[16:31]
    buffer_load_dwordx4 v[176:179], v1, s[16:19], s32 offen offset:0 sc1
    buffer_load_dwordx4 v[180:183], v1, s[16:19], s32 offen offset:1024 sc1
    s_waitcnt lgkmcnt(2)
    v_mfma_f32_32x32x16_bf16 v[32:47], v[108:111], v[236:239], v[32:47]
    s_waitcnt lgkmcnt(1)
    v_mfma_f32_32x32x16_bf16 v[16:31], v[252:255], v[244:247], v[16:31]
    s_waitcnt lgkmcnt(0)
    v_mfma_f32_32x32x16_bf16 v[32:47], v[240:243], v[244:247], v[32:47]
    s_waitcnt vmcnt(13)
    v_mfma_f32_32x32x16_bf16 v[64:79], v[48:51], v[128:131], 0
    s_nop 7
    v_mul_f32 v16, v8, v16
    v_mul_f32 v17, v8, v17
    v_cvt_pk_bf16_f32 v16, v16, v17
    v_mul_f32 v18, v8, v18
    v_mul_f32 v19, v8, v19
    v_cvt_pk_bf16_f32 v17, v18, v19
    s_waitcnt vmcnt(12)
    v_mfma_f32_32x32x16_bf16 v[64:79], v[52:55], v[132:135], v[64:79]
    v_mul_f32 v20, v8, v20
    v_mul_f32 v21, v8, v21
    v_cvt_pk_bf16_f32 v18, v20, v21
    v_mul_f32 v22, v8, v22
    v_mul_f32 v23, v8, v23
    v_cvt_pk_bf16_f32 v19, v22, v23
    ds_write_b128 v9, v[16:19] offset:57344
    s_waitcnt vmcnt(11)
    v_mfma_f32_32x32x16_bf16 v[80:95], v[48:51], v[136:139], 0
    v_mul_f32 v24, v8, v24
    v_mul_f32 v25, v8, v25
    v_cvt_pk_bf16_f32 v20, v24, v25
    v_mul_f32 v26, v8, v26
    v_mul_f32 v27, v8, v27
    v_cvt_pk_bf16_f32 v21, v26, v27
    s_waitcnt vmcnt(10)
    v_mfma_f32_32x32x16_bf16 v[80:95], v[52:55], v[140:143], v[80:95]
    v_mul_f32 v28, v8, v28
    v_mul_f32 v29, v8, v29
    v_cvt_pk_bf16_f32 v22, v28, v29
    v_mul_f32 v30, v8, v30
    v_mul_f32 v31, v8, v31
    v_cvt_pk_bf16_f32 v23, v30, v31
    ds_write_b128 v9, v[20:23] offset:58368
    s_waitcnt vmcnt(9)
    v_mfma_f32_32x32x16_bf16 v[96:111], v[48:51], v[144:147], 0
    v_mul_f32 v32, v8, v32
    v_mul_f32 v33, v8, v33
    v_cvt_pk_bf16_f32 v32, v32, v33
    v_mul_f32 v34, v8, v34
    v_mul_f32 v35, v8, v35
    v_cvt_pk_bf16_f32 v33, v34, v35
    s_waitcnt vmcnt(8)
    v_mfma_f32_32x32x16_bf16 v[96:111], v[52:55], v[148:151], v[96:111]
    v_mul_f32 v36, v8, v36
    v_mul_f32 v37, v8, v37
    v_cvt_pk_bf16_f32 v34, v36, v37
    v_mul_f32 v38, v8, v38
    v_mul_f32 v39, v8, v39
    v_cvt_pk_bf16_f32 v35, v38, v39
    ds_write_b128 v10, v[32:35] offset:32768
    s_waitcnt vmcnt(7)
    v_mfma_f32_32x32x16_bf16 v[112:127], v[48:51], v[152:155], 0
    v_mul_f32 v40, v8, v40
    v_mul_f32 v41, v8, v41
    v_cvt_pk_bf16_f32 v36, v40, v41
    v_mul_f32 v42, v8, v42
    v_mul_f32 v43, v8, v43
    v_cvt_pk_bf16_f32 v37, v42, v43
    s_waitcnt vmcnt(6)
    v_mfma_f32_32x32x16_bf16 v[112:127], v[52:55], v[156:159], v[112:127]
    v_mul_f32 v44, v8, v44
    v_mul_f32 v45, v8, v45
    v_cvt_pk_bf16_f32 v38, v44, v45
    v_mul_f32 v46, v8, v46
    v_mul_f32 v47, v8, v47
    v_cvt_pk_bf16_f32 v39, v46, v47
    ds_write_b128 v10, v[36:39] offset:33792
    s_waitcnt lgkmcnt(0)
    s_barrier
    s_branch K_ATT
K_SHORT:
    s_waitcnt lgkmcnt(5)
    v_mfma_f32_32x32x16_bf16 v[16:31], v[100:103], v[236:239], v[16:31]
    s_waitcnt lgkmcnt(3)
    v_mfma_f32_32x32x16_bf16 v[32:47], v[104:107], v[236:239], v[32:47]
    s_waitcnt lgkmcnt(1)
    v_mfma_f32_32x32x16_bf16 v[48:63], v[108:111], v[236:239], v[48:63]
    s_waitcnt lgkmcnt(0)
    s_barrier
    ds_read_b128 v[240:243], v6 offset:0
    ds_read_b128 v[248:251], v6 offset:1024
    ds_read_b128 v[252:255], v6 offset:2048
    s_waitcnt lgkmcnt(2)
    v_mfma_f32_32x32x16_bf16 v[16:31], v[240:243], v[244:247], v[16:31]
    s_waitcnt lgkmcnt(1)
    v_mfma_f32_32x32x16_bf16 v[32:47], v[248:251], v[244:247], v[32:47]
    s_waitcnt lgkmcnt(0)
    v_mfma_f32_32x32x16_bf16 v[48:63], v[252:255], v[244:247], v[48:63]
    s_cmp_lt_u32 s30, 16
    s_cselect_b32 s23, 0x3e8b97f6, 1.0
    v_mul_f32 v7, s23, v8
    s_nop 4
    v_pk_mul_f32 v[16:17], v[16:17], v[6:7] op_sel:[0,1]
    v_cvt_pk_bf16_f32 v16, v16, v17
    v_pk_mul_f32 v[18:19], v[18:19], v[6:7] op_sel:[0,1]
    v_cvt_pk_bf16_f32 v17, v18, v19
    v_pk_mul_f32 v[20:21], v[20:21], v[6:7] op_sel:[0,1]
    v_cvt_pk_bf16_f32 v18, v20, v21
    v_pk_mul_f32 v[22:23], v[22:23], v[6:7] op_sel:[0,1]
    v_cvt_pk_bf16_f32 v19, v22, v23
    ds_write_b128 v9, v[16:19] offset:0
    v_pk_mul_f32 v[24:25], v[24:25], v[6:7] op_sel:[0,1]
    v_cvt_pk_bf16_f32 v20, v24, v25
    v_pk_mul_f32 v[26:27], v[26:27], v[6:7] op_sel:[0,1]
    v_cvt_pk_bf16_f32 v21, v26, v27
    v_pk_mul_f32 v[28:29], v[28:29], v[6:7] op_sel:[0,1]
    v_cvt_pk_bf16_f32 v22, v28, v29
    v_pk_mul_f32 v[30:31], v[30:31], v[6:7] op_sel:[0,1]
    v_cvt_pk_bf16_f32 v23, v30, v31
    ds_write_b128 v9, v[20:23] offset:1024
    s_cmp_lt_u32 s30, 15
    s_cselect_b32 s23, 0x3e8b97f6, 1.0
    v_mul_f32 v7, s23, v8
    v_pk_mul_f32 v[32:33], v[32:33], v[6:7] op_sel:[0,1]
    v_cvt_pk_bf16_f32 v32, v32, v33
    v_pk_mul_f32 v[34:35], v[34:35], v[6:7] op_sel:[0,1]
    v_cvt_pk_bf16_f32 v33, v34, v35
    v_pk_mul_f32 v[36:37], v[36:37], v[6:7] op_sel:[0,1]
    v_cvt_pk_bf16_f32 v34, v36, v37
    v_pk_mul_f32 v[38:39], v[38:39], v[6:7] op_sel:[0,1]
    v_cvt_pk_bf16_f32 v35, v38, v39
    ds_write_b128 v9, v[32:35] offset:8192
    v_pk_mul_f32 v[40:41], v[40:41], v[6:7] op_sel:[0,1]
    v_cvt_pk_bf16_f32 v36, v40, v41
    v_pk_mul_f32 v[42:43], v[42:43], v[6:7] op_sel:[0,1]
    v_cvt_pk_bf16_f32 v37, v42, v43
    v_pk_mul_f32 v[44:45], v[44:45], v[6:7] op_sel:[0,1]
    v_cvt_pk_bf16_f32 v38, v44, v45
    v_pk_mul_f32 v[46:47], v[46:47], v[6:7] op_sel:[0,1]
    v_cvt_pk_bf16_f32 v39, v46, v47
    ds_write_b128 v9, v[36:39] offset:9216
    s_cmp_lt_u32 s30, 14
    s_cselect_b32 s23, 0x3e8b97f6, 1.0
    v_mul_f32 v7, s23, v8
    v_pk_mul_f32 v[48:49], v[48:49], v[6:7] op_sel:[0,1]
    v_cvt_pk_bf16_f32 v48, v48, v49
    v_pk_mul_f32 v[50:51], v[50:51], v[6:7] op_sel:[0,1]
    v_cvt_pk_bf16_f32 v49, v50, v51
    v_pk_mul_f32 v[52:53], v[52:53], v[6:7] op_sel:[0,1]
    v_cvt_pk_bf16_f32 v50, v52, v53
    v_pk_mul_f32 v[54:55], v[54:55], v[6:7] op_sel:[0,1]
    v_cvt_pk_bf16_f32 v51, v54, v55
    ds_write_b128 v9, v[48:51] offset:16384
    v_pk_mul_f32 v[56:57], v[56:57], v[6:7] op_sel:[0,1]
    v_cvt_pk_bf16_f32 v52, v56, v57
    v_pk_mul_f32 v[58:59], v[58:59], v[6:7] op_sel:[0,1]
    v_cvt_pk_bf16_f32 v53, v58, v59
    v_pk_mul_f32 v[60:61], v[60:61], v[6:7] op_sel:[0,1]
    v_cvt_pk_bf16_f32 v54, v60, v61
    v_pk_mul_f32 v[62:63], v[62:63], v[6:7] op_sel:[0,1]
    v_cvt_pk_bf16_f32 v55, v62, v63
    ds_write_b128 v9, v[52:55] offset:17408
    s_waitcnt lgkmcnt(0)
    s_barrier
    s_barrier
    s_mov_b32 s35, 262144
K_PQ2:
    s_sleep 10
    buffer_load_dword v14, v15, s[16:19], 0 offen sc1
    s_sub_u32 s35, s35, 1
    s_cmp_eq_u32 s35, 0
    s_waitcnt vmcnt(0)
    s_cbranch_scc1 K_PQ2X
    v_cmp_ne_u32 vcc, s34, v14
    s_nop 1
    s_cbranch_vccnz K_PQ2
K_PQ2X:
    s_lshl_b32 s33, s38, 18
    s_add_u32 s33, s33, 2097152
    buffer_load_dwordx4 v[48:51], v1, s[16:19], s33 offen sc1
    buffer_load_dwordx4 v[52:55], v1, s[16:19], s33 offen offset:1024 sc1
    s_lshl_b32 s23, s38, 6
    s_lshl_b32 s24, s39, 2
    s_add_u32 s23, s23, s24
    s_xor_b32 s24, s20, 1
    s_add_u32 s24, s24, s23
    s_lshl_b32 s24, s24, 11
    buffer_load_dwordx4 v[128:131], v1, s[16:19], s24 offen sc1
    buffer_load_dwordx4 v[132:135], v1, s[16:19], s24 offen offset:1024 sc1
    s_xor_b32 s24, s20, 2
    s_add_u32 s24, s24, s23
    s_lshl_b32 s24, s24, 11
    buffer_load_dwordx4 v[136:139], v1, s[16:19], s24 offen sc1
    buffer_load_dwordx4 v[140:143], v1, s[16:19], s24 offen offset:1024 sc1
    s_xor_b32 s24, s20, 3
    s_add_u32 s24, s24, s23
    s_lshl_b32 s24, s24, 11
    buffer_load_dwordx4 v[144:147], v1, s[16:19], s24 offen sc1
    buffer_load_dwordx4 v[148:151], v1, s[16:19], s24 offen offset:1024 sc1
    s_xor_b32 s24, s20, 0
    s_add_u32 s24, s24, s23
    s_lshl_b32 s24, s24, 11
    buffer_load_dwordx4 v[152:155], v1, s[16:19], s24 offen sc1
    buffer_load_dwordx4 v[156:159], v1, s[16:19], s24 offen offset:1024 sc1
    s_lshl_b32 s23, s20, 16
    s_add_u32 s29, s33, s23
    s_add_u32 s32, s29, 4096
    buffer_load_dwordx4 v[160:163], v1, s[16:19], s29 offen offset:0 sc1
    buffer_load_dwordx4 v[164:167], v1, s[16:19], s29 offen offset:1024 sc1
    buffer_load_dwordx4 v[168:171], v1, s[16:19], s29 offen offset:2048 sc1
    buffer_load_dwordx4 v[172:175], v1, s[16:19], s29 offen offset:3072 sc1
    buffer_load_dwordx4 v[176:179], v1, s[16:19], s32 offen offset:0 sc1
    buffer_load_dwordx4 v[180:183], v1, s[16:19], s32 offen offset:1024 sc1
    s_waitcnt vmcnt(13)
    v_mfma_f32_32x32x16_bf16 v[64:79], v[48:51], v[128:131], 0
    s_waitcnt vmcnt(12)
    v_mfma_f32_32x32x16_bf16 v[64:79], v[52:55], v[132:135], v[64:79]
    s_waitcnt vmcnt(11)
    v_mfma_f32_32x32x16_bf16 v[80:95], v[48:51], v[136:139], 0
    s_waitcnt vmcnt(10)
    v_mfma_f32_32x32x16_bf16 v[80:95], v[52:55], v[140:143], v[80:95]
    s_waitcnt vmcnt(9)
    v_mfma_f32_32x32x16_bf16 v[96:111], v[48:51], v[144:147], 0
    s_waitcnt vmcnt(8)
    v_mfma_f32_32x32x16_bf16 v[96:111], v[52:55], v[148:151], v[96:111]
    s_waitcnt vmcnt(7)
    v_mfma_f32_32x32x16_bf16 v[112:127], v[48:51], v[152:155], 0
    s_waitcnt vmcnt(6)
    v_mfma_f32_32x32x16_bf16 v[112:127], v[52:55], v[156:159], v[112:127]
    s_nop 7
K_ATT:
    s_setprio 2
    s_mov_b32 s56, s16
    s_mov_b32 s57, s17
    s_add_u32 s58, s29, 65536
    s_mov_b32 s59, 0x00020000
    v_mov_b32 v6, s34
    s_xor_b32 s23, s20, 1
    s_mul_i32 s23, s23, 3
    s_add_u32 s23, s23, 0
    s_lshl_b32 s23, s23, 12
    v_add_u32 v2, s23, v1
    s_xor_b32 s23, s20, 2
    s_mul_i32 s23, s23, 3
    s_add_u32 s23, s23, 1
    s_lshl_b32 s23, s23, 12
    v_add_u32 v3, s23, v1
    s_xor_b32 s23, s20, 3
    s_mul_i32 s23, s23, 3
    s_add_u32 s23, s23, 2
    s_lshl_b32 s23, s23, 12
    v_add_u32 v4, s23, v1
    s_mul_i32 s23, s20, 12288
    v_add_u32 v5, s23, v1
    s_mov_b32 s35, 8
    v_max3_f32 v24, v64, v65, v66
    v_max3_f32 v24, v24, v67, v68
    v_max3_f32 v24, v24, v69, v70
    v_max3_f32 v24, v24, v71, v72
    v_max3_f32 v24, v24, v73, v74
    v_max3_f32 v24, v24, v75, v76
    v_max3_f32 v24, v24, v77, v78
    v_max_f32 v24, v24, v79
    v_max3_f32 v25, v80, v81, v82
    v_max3_f32 v25, v25, v83, v84
    v_max3_f32 v25, v25, v85, v86
    v_max3_f32 v25, v25, v87, v88
    v_max3_f32 v25, v25, v89, v90
    v_max3_f32 v25, v25, v91, v92
    v_max3_f32 v25, v25, v93, v94
    v_max_f32 v25, v25, v95
    v_max3_f32 v26, v96, v97, v98
    v_max3_f32 v26, v26, v99, v100
    v_max3_f32 v26, v26, v101, v102
    v_max3_f32 v26, v26, v103, v104
    v_max3_f32 v26, v26, v105, v106
    v_max3_f32 v26, v26, v107, v108
    v_max3_f32 v26, v26, v109, v110
    v_max_f32 v26, v26, v111
    v_max3_f32 v27, v112, v113, v114
    v_max3_f32 v27, v27, v115, v116
    v_max3_f32 v27, v27, v117, v118
    v_max3_f32 v27, v27, v119, v120
    v_max3_f32 v27, v27, v121, v122
    v_max3_f32 v27, v27, v123, v124
    v_max3_f32 v27, v27, v125, v126
    v_max_f32 v27, v27, v127
    v_mov_b32 v28, v24
    v_mov_b32 v29, v25
    v_mov_b32 v30, v26
    v_mov_b32 v31, v27
    v_permlane32_swap_b32 v24, v28
    v_permlane32_swap_b32 v25, v29
    v_permlane32_swap_b32 v26, v30
    v_permlane32_swap_b32 v27, v31
    v_max_f32 v24, v24, v28
    v_sub_f32 v28, 0xc2b40000, v24
    v_and_b32 v40, 0xffff0000, v28
    v_sub_f32 v28, v28, v40
    v_and_b32 v44, 0xffff0000, v28
    v_sub_f32 v28, v28, v44
    v_lshrrev_b32 v40, 16, v40
    v_or_b32 v40, v40, v44
    v_lshrrev_b32 v28, 16, v28
    v_max_f32 v25, v25, v29
    v_sub_f32 v29, 0xc2b40000, v25
    v_and_b32 v41, 0xffff0000, v29
    v_sub_f32 v29, v29, v41
    v_and_b32 v45, 0xffff0000, v29
    v_sub_f32 v29, v29, v45
    v_lshrrev_b32 v41, 16, v41
    v_or_b32 v41, v41, v45
    v_lshrrev_b32 v29, 16, v29
    v_max_f32 v26, v26, v30
    v_sub_f32 v30, 0xc2b40000, v26
    v_and_b32 v42, 0xffff0000, v30
    v_sub_f32 v30, v30, v42
    v_and_b32 v46, 0xffff0000, v30
    v_sub_f32 v30, v30, v46
    v_lshrrev_b32 v42, 16, v42
    v_or_b32 v42, v42, v46
    v_lshrrev_b32 v30, 16, v30
    v_max_f32 v27, v27, v31
    v_sub_f32 v31, 0xc2b40000, v27
    v_and_b32 v43, 0xffff0000, v31
    v_sub_f32 v31, v31, v43
    v_and_b32 v47, 0xffff0000, v31
    v_sub_f32 v31, v31, v47
    v_lshrrev_b32 v43, 16, v43
    v_or_b32 v43, v43, v47
    v_lshrrev_b32 v31, 16, v31
    s_mov_b32 exec_lo, 0
    v_mov_b32 v134, v40
    v_mov_b32 v135, v28
    v_mov_b32 v142, v41
    v_mov_b32 v143, v29
    v_mov_b32 v150, v42
    v_mov_b32 v151, v30
    v_mov_b32 v158, v43
    v_mov_b32 v159, v31
    s_mov_b32 exec_lo, -1
    s_waitcnt vmcnt(5)
    v_mfma_f32_32x32x16_bf16 v[48:63], v[160:163], v[128:131], 0
    s_waitcnt vmcnt(4)
    v_mfma_f32_32x32x16_bf16 v[48:63], v[164:167], v[132:135], v[48:63]
    v_mov_b64 v[192:193], 0
    v_mov_b64 v[194:195], 0
    v_mov_b64 v[196:197], 0
    v_mov_b64 v[198:199], 0
    v_mov_b64 v[200:201], 0
    v_mov_b64 v[202:203], 0
    v_mov_b64 v[204:205], 0
    v_mov_b64 v[206:207], 0
    v_mov_b64 v[208:209], 0
    v_mov_b64 v[210:211], 0
    v_mov_b64 v[212:213], 0
    v_mov_b64 v[214:215], 0
    v_mov_b64 v[216:217], 0
    v_mov_b64 v[218:219], 0
    v_mov_b64 v[220:221], 0
    v_mov_b64 v[222:223], 0
    v_mov_b64 v[224:225], 0
    v_mov_b64 v[226:227], 0
    v_mov_b64 v[228:229], 0
    v_mov_b64 v[230:231], 0
    v_mov_b64 v[232:233], 0
    v_mov_b64 v[234:235], 0
    v_mov_b64 v[236:237], 0
    v_mov_b64 v[238:239], 0
    v_mov_b64 v[184:185], 0
    v_mov_b64 v[186:187], 0
    v_mov_b64 v[188:189], 0
    v_mov_b64 v[190:191], 0
    v_mov_b64 v[96:97], 0
    v_mov_b64 v[98:99], 0
    v_mov_b64 v[100:101], 0
    v_mov_b64 v[102:103], 0
    v_mov_b64 v[104:105], 0
    v_mov_b64 v[106:107], 0
    v_mov_b64 v[108:109], 0
    v_mov_b64 v[110:111], 0
    v_mov_b64 v[88:89], 0
    v_mov_b64 v[90:91], 0
    v_mov_b64 v[92:93], 0
    v_mov_b64 v[94:95], 0
    .p2align 6
K_LOOP:
    v_mfma_f32_32x32x16_bf16 v[64:79], v[160:163], v[136:139], 0
    v_exp_f32 v48, v48
    v_exp_f32 v49, v49
    v_exp_f32 v50, v50
    v_exp_f32 v51, v51
    v_cvt_pk_bf16_f32 v80, v48, v49
    v_exp_f32 v52, v52
    v_mfma_f32_32x32x16_bf16 v[64:79], v[164:167], v[140:143], v[64:79]
    v_exp_f32 v53, v53
    v_cvt_pk_bf16_f32 v81, v50, v51
    v_exp_f32 v54, v54
    v_exp_f32 v55, v55
    v_cvt_pk_bf16_f32 v82, v52, v53
    v_exp_f32 v56, v56
    v_mfma_f32_32x32x16_bf16 v[96:111], v[184:187], v[88:91], v[96:111]
    v_exp_f32 v57, v57
    v_cvt_pk_bf16_f32 v83, v54, v55
    v_exp_f32 v58, v58
    v_exp_f32 v59, v59
    v_cvt_pk_bf16_f32 v84, v56, v57
    v_exp_f32 v60, v60
    v_mfma_f32_32x32x16_bf16 v[96:111], v[188:191], v[92:95], v[96:111]
    v_exp_f32 v61, v61
    v_cvt_pk_bf16_f32 v85, v58, v59
    v_exp_f32 v62, v62
    buffer_load_dwordx4 v[184:187], v1, s[56:59], s32 offen offset:2048 sc1
    v_exp_f32 v63, v63
    v_cvt_pk_bf16_f32 v86, v60, v61
    v_cvt_pk_bf16_f32 v87, v62, v63
    buffer_load_dwordx4 v[188:191], v1, s[56:59], s32 offen offset:3072 sc1
    s_add_u32 s29, s29, 8192
    v_mfma_f32_32x32x16_bf16 v[48:63], v[160:163], v[144:147], 0
    v_exp_f32 v64, v64
    v_exp_f32 v65, v65
    v_exp_f32 v66, v66
    v_exp_f32 v67, v67
    v_cvt_pk_bf16_f32 v88, v64, v65
    v_exp_f32 v68, v68
    v_mfma_f32_32x32x16_bf16 v[48:63], v[164:167], v[148:151], v[48:63]
    v_exp_f32 v69, v69
    v_cvt_pk_bf16_f32 v89, v66, v67
    v_exp_f32 v70, v70
    v_exp_f32 v71, v71
    v_cvt_pk_bf16_f32 v90, v68, v69
    v_exp_f32 v72, v72
    s_waitcnt vmcnt(5)
    v_mfma_f32_32x32x16_bf16 v[192:207], v[168:171], v[80:83], v[192:207]
    v_exp_f32 v73, v73
    v_cvt_pk_bf16_f32 v91, v70, v71
    v_exp_f32 v74, v74
    v_exp_f32 v75, v75
    v_cvt_pk_bf16_f32 v92, v72, v73
    v_exp_f32 v76, v76
    s_waitcnt vmcnt(4)
    v_mfma_f32_32x32x16_bf16 v[192:207], v[172:175], v[84:87], v[192:207]
    v_exp_f32 v77, v77
    v_cvt_pk_bf16_f32 v93, v74, v75
    v_exp_f32 v78, v78
    v_exp_f32 v79, v79
    v_cvt_pk_bf16_f32 v94, v76, v77
    v_cvt_pk_bf16_f32 v95, v78, v79
    v_mfma_f32_32x32x16_bf16 v[64:79], v[160:163], v[152:155], 0
    v_exp_f32 v48, v48
    v_exp_f32 v49, v49
    v_exp_f32 v50, v50
    v_exp_f32 v51, v51
    v_cvt_pk_bf16_f32 v80, v48, v49
    v_exp_f32 v52, v52
    v_mfma_f32_32x32x16_bf16 v[64:79], v[164:167], v[156:159], v[64:79]
    v_exp_f32 v53, v53
    v_cvt_pk_bf16_f32 v81, v50, v51
    v_exp_f32 v54, v54
    v_exp_f32 v55, v55
    v_cvt_pk_bf16_f32 v82, v52, v53
    v_exp_f32 v56, v56
    v_mfma_f32_32x32x16_bf16 v[208:223], v[168:171], v[88:91], v[208:223]
    v_exp_f32 v57, v57
    v_cvt_pk_bf16_f32 v83, v54, v55
    v_exp_f32 v58, v58
    v_exp_f32 v59, v59
    v_cvt_pk_bf16_f32 v84, v56, v57
    v_exp_f32 v60, v60
    v_mfma_f32_32x32x16_bf16 v[208:223], v[172:175], v[92:95], v[208:223]
    v_exp_f32 v61, v61
    v_cvt_pk_bf16_f32 v85, v58, v59
    v_exp_f32 v62, v62
    buffer_load_dwordx4 v[160:163], v1, s[56:59], s29 offen offset:0 sc1
    v_exp_f32 v63, v63
    v_cvt_pk_bf16_f32 v86, v60, v61
    v_cvt_pk_bf16_f32 v87, v62, v63
    buffer_load_dwordx4 v[164:167], v1, s[56:59], s29 offen offset:1024 sc1
    s_waitcnt vmcnt(5)
    v_mfma_f32_32x32x16_bf16 v[48:63], v[176:179], v[128:131], 0
    v_exp_f32 v64, v64
    v_exp_f32 v65, v65
    v_exp_f32 v66, v66
    v_exp_f32 v67, v67
    v_cvt_pk_bf16_f32 v88, v64, v65
    v_exp_f32 v68, v68
    s_waitcnt vmcnt(4)
    v_mfma_f32_32x32x16_bf16 v[48:63], v[180:183], v[132:135], v[48:63]
    v_exp_f32 v69, v69
    v_cvt_pk_bf16_f32 v89, v66, v67
    v_exp_f32 v70, v70
    v_exp_f32 v71, v71
    v_cvt_pk_bf16_f32 v90, v68, v69
    v_exp_f32 v72, v72
    v_mfma_f32_32x32x16_bf16 v[224:239], v[168:171], v[80:83], v[224:239]
    v_exp_f32 v73, v73
    v_cvt_pk_bf16_f32 v91, v70, v71
    v_exp_f32 v74, v74
    v_exp_f32 v75, v75
    v_cvt_pk_bf16_f32 v92, v72, v73
    v_exp_f32 v76, v76
    v_mfma_f32_32x32x16_bf16 v[224:239], v[172:175], v[84:87], v[224:239]
    v_exp_f32 v77, v77
    v_cvt_pk_bf16_f32 v93, v74, v75
    v_exp_f32 v78, v78
    v_exp_f32 v79, v79
    v_cvt_pk_bf16_f32 v94, v76, v77
    v_cvt_pk_bf16_f32 v95, v78, v79
    v_mfma_f32_32x32x16_bf16 v[64:79], v[176:179], v[136:139], 0
    v_exp_f32 v48, v48
    v_exp_f32 v49, v49
    v_exp_f32 v50, v50
    v_exp_f32 v51, v51
    v_cvt_pk_bf16_f32 v80, v48, v49
    v_exp_f32 v52, v52
    v_mfma_f32_32x32x16_bf16 v[64:79], v[180:183], v[140:143], v[64:79]
    v_exp_f32 v53, v53
    v_cvt_pk_bf16_f32 v81, v50, v51
    v_exp_f32 v54, v54
    v_exp_f32 v55, v55
    v_cvt_pk_bf16_f32 v82, v52, v53
    v_exp_f32 v56, v56
    v_mfma_f32_32x32x16_bf16 v[96:111], v[168:171], v[88:91], v[96:111]
    v_exp_f32 v57, v57
    v_cvt_pk_bf16_f32 v83, v54, v55
    v_exp_f32 v58, v58
    v_exp_f32 v59, v59
    v_cvt_pk_bf16_f32 v84, v56, v57
    v_exp_f32 v60, v60
    v_mfma_f32_32x32x16_bf16 v[96:111], v[172:175], v[92:95], v[96:111]
    v_exp_f32 v61, v61
    v_cvt_pk_bf16_f32 v85, v58, v59
    v_exp_f32 v62, v62
    buffer_load_dwordx4 v[168:171], v1, s[56:59], s29 offen offset:2048 sc1
    v_exp_f32 v63, v63
    v_cvt_pk_bf16_f32 v86, v60, v61
    v_cvt_pk_bf16_f32 v87, v62, v63
    buffer_load_dwordx4 v[172:175], v1, s[56:59], s29 offen offset:3072 sc1
    s_add_u32 s32, s32, 8192
    v_mfma_f32_32x32x16_bf16 v[48:63], v[176:179], v[144:147], 0
    v_exp_f32 v64, v64
    v_exp_f32 v65, v65
    v_exp_f32 v66, v66
    v_exp_f32 v67, v67
    v_cvt_pk_bf16_f32 v88, v64, v65
    v_exp_f32 v68, v68
    v_mfma_f32_32x32x16_bf16 v[48:63], v[180:183], v[148:151], v[48:63]
    v_exp_f32 v69, v69
    v_cvt_pk_bf16_f32 v89, v66, v67
    v_exp_f32 v70, v70
    v_exp_f32 v71, v71
    v_cvt_pk_bf16_f32 v90, v68, v69
    v_exp_f32 v72, v72
    s_waitcnt vmcnt(5)
    v_mfma_f32_32x32x16_bf16 v[192:207], v[184:187], v[80:83], v[192:207]
    v_exp_f32 v73, v73
    v_cvt_pk_bf16_f32 v91, v70, v71
    v_exp_f32 v74, v74
    v_exp_f32 v75, v75
    v_cvt_pk_bf16_f32 v92, v72, v73
    v_exp_f32 v76, v76
    s_waitcnt vmcnt(4)
    v_mfma_f32_32x32x16_bf16 v[192:207], v[188:191], v[84:87], v[192:207]
    v_exp_f32 v77, v77
    v_cvt_pk_bf16_f32 v93, v74, v75
    v_exp_f32 v78, v78
    v_exp_f32 v79, v79
    v_cvt_pk_bf16_f32 v94, v76, v77
    v_cvt_pk_bf16_f32 v95, v78, v79
    v_mfma_f32_32x32x16_bf16 v[64:79], v[176:179], v[152:155], 0
    v_exp_f32 v48, v48
    v_exp_f32 v49, v49
    v_exp_f32 v50, v50
    v_exp_f32 v51, v51
    v_cvt_pk_bf16_f32 v80, v48, v49
    v_exp_f32 v52, v52
    v_mfma_f32_32x32x16_bf16 v[64:79], v[180:183], v[156:159], v[64:79]
    v_exp_f32 v53, v53
    v_cvt_pk_bf16_f32 v81, v50, v51
    v_exp_f32 v54, v54
    v_exp_f32 v55, v55
    v_cvt_pk_bf16_f32 v82, v52, v53
    v_exp_f32 v56, v56
    v_mfma_f32_32x32x16_bf16 v[208:223], v[184:187], v[88:91], v[208:223]
    v_exp_f32 v57, v57
    v_cvt_pk_bf16_f32 v83, v54, v55
    v_exp_f32 v58, v58
    v_exp_f32 v59, v59
    v_cvt_pk_bf16_f32 v84, v56, v57
    v_exp_f32 v60, v60
    v_mfma_f32_32x32x16_bf16 v[208:223], v[188:191], v[92:95], v[208:223]
    v_exp_f32 v61, v61
    v_cvt_pk_bf16_f32 v85, v58, v59
    v_exp_f32 v62, v62
    buffer_load_dwordx4 v[176:179], v1, s[56:59], s32 offen offset:0 sc1
    v_exp_f32 v63, v63
    v_cvt_pk_bf16_f32 v86, v60, v61
    v_cvt_pk_bf16_f32 v87, v62, v63
    buffer_load_dwordx4 v[180:183], v1, s[56:59], s32 offen offset:1024 sc1
    s_sub_u32 s35, s35, 1
    s_cmp_lg_u32 s35, 0
    s_waitcnt vmcnt(5)
    v_mfma_f32_32x32x16_bf16 v[48:63], v[160:163], v[128:131], 0
    v_exp_f32 v64, v64
    v_exp_f32 v65, v65
    v_exp_f32 v66, v66
    v_exp_f32 v67, v67
    v_cvt_pk_bf16_f32 v88, v64, v65
    v_exp_f32 v68, v68
    s_waitcnt vmcnt(4)
    v_mfma_f32_32x32x16_bf16 v[48:63], v[164:167], v[132:135], v[48:63]
    v_exp_f32 v69, v69
    v_cvt_pk_bf16_f32 v89, v66, v67
    v_exp_f32 v70, v70
    v_exp_f32 v71, v71
    v_cvt_pk_bf16_f32 v90, v68, v69
    v_exp_f32 v72, v72
    v_mfma_f32_32x32x16_bf16 v[224:239], v[184:187], v[80:83], v[224:239]
    v_exp_f32 v73, v73
    v_cvt_pk_bf16_f32 v91, v70, v71
    v_exp_f32 v74, v74
    v_exp_f32 v75, v75
    v_cvt_pk_bf16_f32 v92, v72, v73
    v_exp_f32 v76, v76
    v_mfma_f32_32x32x16_bf16 v[224:239], v[188:191], v[84:87], v[224:239]
    v_exp_f32 v77, v77
    v_cvt_pk_bf16_f32 v93, v74, v75
    v_exp_f32 v78, v78
    v_exp_f32 v79, v79
    v_cvt_pk_bf16_f32 v94, v76, v77
    v_cvt_pk_bf16_f32 v95, v78, v79
    s_cbranch_scc1 K_LOOP
    v_mfma_f32_32x32x16_bf16 v[96:111], v[184:187], v[88:91], v[96:111]
    v_mfma_f32_32x32x16_bf16 v[96:111], v[188:191], v[92:95], v[96:111]
    ds_write_b128 v2, v[192:195] offset:0
    ds_write_b128 v2, v[196:199] offset:1024
    ds_write_b128 v2, v[200:203] offset:2048
    ds_write_b128 v2, v[204:207] offset:3072
    ds_write_b128 v3, v[208:211] offset:0
    ds_write_b128 v3, v[212:215] offset:1024
    ds_write_b128 v3, v[216:219] offset:2048
    ds_write_b128 v3, v[220:223] offset:3072
    ds_write_b128 v4, v[224:227] offset:0
    ds_write_b128 v4, v[228:231] offset:1024
    ds_write_b128 v4, v[232:235] offset:2048
    ds_write_b128 v4, v[236:239] offset:3072
    s_lshl_b32 s24, s39, 2
    s_add_u32 s24, s24, s20
    s_lshl_b32 s23, s24, 15
    s_lshl_b32 s25, s38, 11
    s_add_u32 s23, s23, s25
    s_add_u32 s23, s23, 16777216
    s_lshl_b32 s25, s24, 4
    s_add_u32 s25, s25, s38
    s_lshl_b32 s25, s25, 2
    s_add_u32 s25, s25, 18886656
    s_lshl_b32 s24, s20, 2
    s_add_u32 s24, s24, 154640
    v_mov_b32 v16, s24
    v_and_b32 v17, 3, v0
    v_lshlrev_b32 v17, 2, v17
    v_add_u32 v17, 154640, v17
    ds_write_b32 v16, v6
    s_mov_b32 s29, 4194304
K_AW:
    ds_read_b32 v18, v17
    s_sub_u32 s29, s29, 1
    s_cmp_eq_u32 s29, 0
    s_waitcnt lgkmcnt(0)
    s_cbranch_scc1 K_AWX
    v_cmp_ne_u32 vcc, s34, v18
    s_nop 1
    s_cbranch_vccnz K_AW
K_AWX:
    ds_read_b128 v[48:51], v5 offset:0
    ds_read_b128 v[52:55], v5 offset:1024
    ds_read_b128 v[56:59], v5 offset:2048
    ds_read_b128 v[60:63], v5 offset:3072
    ds_read_b128 v[64:67], v5 offset:4096
    ds_read_b128 v[68:71], v5 offset:5120
    ds_read_b128 v[72:75], v5 offset:6144
    ds_read_b128 v[76:79], v5 offset:7168
    ds_read_b128 v[80:83], v5 offset:8192
    ds_read_b128 v[84:87], v5 offset:9216
    ds_read_b128 v[88:91], v5 offset:10240
    ds_read_b128 v[92:95], v5 offset:11264
    s_waitcnt lgkmcnt(11)
    v_pk_add_f32 v[96:97], v[96:97], v[48:49]
    v_pk_add_f32 v[98:99], v[98:99], v[50:51]
    s_waitcnt lgkmcnt(10)
    v_pk_add_f32 v[100:101], v[100:101], v[52:53]
    v_pk_add_f32 v[102:103], v[102:103], v[54:55]
    s_waitcnt lgkmcnt(9)
    v_pk_add_f32 v[104:105], v[104:105], v[56:57]
    v_pk_add_f32 v[106:107], v[106:107], v[58:59]
    s_waitcnt lgkmcnt(8)
    v_pk_add_f32 v[108:109], v[108:109], v[60:61]
    v_pk_add_f32 v[110:111], v[110:111], v[62:63]
    s_waitcnt lgkmcnt(7)
    v_pk_add_f32 v[96:97], v[96:97], v[64:65]
    v_pk_add_f32 v[98:99], v[98:99], v[66:67]
    s_waitcnt lgkmcnt(6)
    v_pk_add_f32 v[100:101], v[100:101], v[68:69]
    v_pk_add_f32 v[102:103], v[102:103], v[70:71]
    s_waitcnt lgkmcnt(5)
    v_pk_add_f32 v[104:105], v[104:105], v[72:73]
    v_pk_add_f32 v[106:107], v[106:107], v[74:75]
    s_waitcnt lgkmcnt(4)
    v_pk_add_f32 v[108:109], v[108:109], v[76:77]
    v_pk_add_f32 v[110:111], v[110:111], v[78:79]
    s_waitcnt lgkmcnt(3)
    v_pk_add_f32 v[96:97], v[96:97], v[80:81]
    v_pk_add_f32 v[98:99], v[98:99], v[82:83]
    s_waitcnt lgkmcnt(2)
    v_pk_add_f32 v[100:101], v[100:101], v[84:85]
    v_pk_add_f32 v[102:103], v[102:103], v[86:87]
    s_waitcnt lgkmcnt(1)
    v_pk_add_f32 v[104:105], v[104:105], v[88:89]
    v_pk_add_f32 v[106:107], v[106:107], v[90:91]
    s_waitcnt lgkmcnt(0)
    v_pk_add_f32 v[108:109], v[108:109], v[92:93]
    v_pk_add_f32 v[110:111], v[110:111], v[94:95]
K_NORM:
    v_mov_b32 v16, v108
    v_mov_b32 v17, v108
    s_nop 1
    v_permlane32_swap_b32 v16, v17
    v_rcp_f32 v18, v17
    s_nop 0
    v_pk_mul_f32 v[96:97], v[96:97], v[18:19] op_sel_hi:[1,0]
    v_pk_mul_f32 v[98:99], v[98:99], v[18:19] op_sel_hi:[1,0]
    v_pk_mul_f32 v[100:101], v[100:101], v[18:19] op_sel_hi:[1,0]
    v_pk_mul_f32 v[102:103], v[102:103], v[18:19] op_sel_hi:[1,0]
    v_pk_mul_f32 v[104:105], v[104:105], v[18:19] op_sel_hi:[1,0]
    v_pk_mul_f32 v[106:107], v[106:107], v[18:19] op_sel_hi:[1,0]
    v_pk_mul_f32 v[108:109], v[108:109], v[18:19] op_sel_hi:[1,0]
    v_pk_mul_f32 v[110:111], v[110:111], v[18:19] op_sel_hi:[1,0]
    v_cvt_pk_bf16_f32 v32, v96, v97
    v_cvt_pk_bf16_f32 v33, v98, v99
    v_cvt_pk_bf16_f32 v34, v100, v101
    v_cvt_pk_bf16_f32 v35, v102, v103
    v_cvt_pk_bf16_f32 v36, v104, v105
    v_cvt_pk_bf16_f32 v37, v106, v107
    v_cvt_pk_bf16_f32 v38, v108, v109
    v_cvt_pk_bf16_f32 v39, v110, v111
    buffer_store_dwordx4 v[32:35], v1, s[16:19], s23 offen sc1
    buffer_store_dwordx4 v[36:39], v1, s[16:19], s23 offen offset:1024 sc1
    v_pk_add_f32 v[96:97], v[96:97], v[96:97] neg_lo:[0,1] neg_hi:[0,1]
    v_pk_add_f32 v[98:99], v[98:99], v[98:99] neg_lo:[0,1] neg_hi:[0,1]
    v_pk_add_f32 v[100:101], v[100:101], v[100:101] neg_lo:[0,1] neg_hi:[0,1]
    v_pk_add_f32 v[102:103], v[102:103], v[102:103] neg_lo:[0,1] neg_hi:[0,1]
    v_pk_add_f32 v[104:105], v[104:105], v[104:105] neg_lo:[0,1] neg_hi:[0,1]
    v_pk_add_f32 v[106:107], v[106:107], v[106:107] neg_lo:[0,1] neg_hi:[0,1]
    v_pk_add_f32 v[108:109], v[108:109], v[108:109] neg_lo:[0,1] neg_hi:[0,1]
    v_pk_add_f32 v[110:111], v[110:111], v[110:111] neg_lo:[0,1] neg_hi:[0,1]
    v_pk_add_f32 v[96:97], v[96:97], v[104:105]
    v_pk_add_f32 v[98:99], v[98:99], v[106:107]
    v_pk_add_f32 v[100:101], v[100:101], v[108:109]
    v_pk_add_f32 v[102:103], v[102:103], v[110:111]
    v_pk_add_f32 v[96:97], v[96:97], v[100:101]
    v_pk_add_f32 v[98:99], v[98:99], v[102:103]
    v_pk_add_f32 v[96:97], v[96:97], v[98:99]
    v_add_f32 v20, v96, v97
    v_add_f32 v20, v20, v17
    v_cmp_ngt_f32 vcc, 0x76800000, v20
    s_cmp_eq_u32 s35, 0
    s_nop 0
    s_cselect_b64 vcc, vcc, 0
    s_cbranch_vccnz K_SLOW
    s_mov_b64 exec, 1
    s_waitcnt vmcnt(0)
    buffer_store_dword v6, v1, s[16:19], s25 offen sc1
    s_mov_b64 exec, -1
    s_endpgm
K_SLOW:
    s_waitcnt vmcnt(0) lgkmcnt(0)
    s_mov_b32 exec_lo, 0
    v_mov_b32 v158, 0
    v_mov_b32 v159, 0
    s_mov_b32 exec_lo, -1
    v_mov_b32 v27, 0xff800000
    s_mov_b32 s29, s33
    s_mov_b32 s35, 64
K_S1:
    buffer_load_dwordx4 v[160:163], v1, s[16:19], s29 offen offset:0 sc1
    buffer_load_dwordx4 v[164:167], v1, s[16:19], s29 offen offset:1024 sc1
    s_waitcnt vmcnt(1)
    v_mfma_f32_32x32x16_bf16 v[48:63], v[160:163], v[152:155], 0
    s_waitcnt vmcnt(0)
    v_mfma_f32_32x32x16_bf16 v[48:63], v[164:167], v[156:159], v[48:63]
    s_nop 11
    v_max3_f32 v27, v27, v48, v49
    v_max3_f32 v27, v27, v50, v51
    v_max3_f32 v27, v27, v52, v53
    v_max3_f32 v27, v27, v54, v55
    v_max3_f32 v27, v27, v56, v57
    v_max3_f32 v27, v27, v58, v59
    v_max3_f32 v27, v27, v60, v61
    v_max3_f32 v27, v27, v62, v63
    s_add_u32 s29, s29, 4096
    s_sub_u32 s35, s35, 1
    s_cmp_lg_u32 s35, 0
    s_cbranch_scc1 K_S1
    v_mov_b32 v31, v27
    s_nop 1
    v_permlane32_swap_b32 v27, v31
    v_max_f32 v27, v27, v31
    v_sub_f32 v31, 0x80000000, v27
    v_and_b32 v43, 0xffff0000, v31
    v_sub_f32 v31, v31, v43
    v_and_b32 v47, 0xffff0000, v31
    v_sub_f32 v31, v31, v47
    v_lshrrev_b32 v43, 16, v43
    v_or_b32 v43, v43, v47
    v_lshrrev_b32 v31, 16, v31
    s_mov_b32 exec_lo, 0
    v_mov_b32 v158, v43
    v_mov_b32 v159, v31
    s_mov_b32 exec_lo, -1
    v_mov_b32 v96, 0
    v_mov_b32 v97, 0
    v_mov_b32 v98, 0
    v_mov_b32 v99, 0
    v_mov_b32 v100, 0
    v_mov_b32 v101, 0
    v_mov_b32 v102, 0
    v_mov_b32 v103, 0
    v_mov_b32 v104, 0
    v_mov_b32 v105, 0
    v_mov_b32 v106, 0
    v_mov_b32 v107, 0
    v_mov_b32 v108, 0
    v_mov_b32 v109, 0
    v_mov_b32 v110, 0
    v_mov_b32 v111, 0
    s_mov_b32 s29, s33
    s_mov_b32 s35, 64
K_S2:
    buffer_load_dwordx4 v[160:163], v1, s[16:19], s29 offen offset:0 sc1
    buffer_load_dwordx4 v[164:167], v1, s[16:19], s29 offen offset:1024 sc1
    buffer_load_dwordx4 v[168:171], v1, s[16:19], s29 offen offset:2048 sc1
    buffer_load_dwordx4 v[172:175], v1, s[16:19], s29 offen offset:3072 sc1
    s_waitcnt vmcnt(3)
    v_mfma_f32_32x32x16_bf16 v[48:63], v[160:163], v[152:155], 0
    s_waitcnt vmcnt(2)
    v_mfma_f32_32x32x16_bf16 v[48:63], v[164:167], v[156:159], v[48:63]
    s_nop 11
    v_exp_f32 v48, v48
    v_exp_f32 v49, v49
    v_exp_f32 v50, v50
    v_exp_f32 v51, v51
    v_cvt_pk_bf16_f32 v80, v48, v49
    v_exp_f32 v52, v52
    v_exp_f32 v53, v53
    v_cvt_pk_bf16_f32 v81, v50, v51
    v_exp_f32 v54, v54
    v_exp_f32 v55, v55
    v_cvt_pk_bf16_f32 v82, v52, v53
    v_exp_f32 v56, v56
    v_exp_f32 v57, v57
    v_cvt_pk_bf16_f32 v83, v54, v55
    v_exp_f32 v58, v58
    v_exp_f32 v59, v59
    v_cvt_pk_bf16_f32 v84, v56, v57
    v_exp_f32 v60, v60
    v_exp_f32 v61, v61
    v_cvt_pk_bf16_f32 v85, v58, v59
    v_exp_f32 v62, v62
    v_exp_f32 v63, v63
    v_cvt_pk_bf16_f32 v86, v60, v61
    v_cvt_pk_bf16_f32 v87, v62, v63
    s_waitcnt vmcnt(1)
    v_mfma_f32_32x32x16_bf16 v[96:111], v[168:171], v[80:83], v[96:111]
    s_waitcnt vmcnt(0)
    v_mfma_f32_32x32x16_bf16 v[96:111], v[172:175], v[84:87], v[96:111]
    s_add_u32 s29, s29, 4096
    s_sub_u32 s35, s35, 1
    s_cmp_lg_u32 s35, 0
    s_cbranch_scc1 K_S2
    s_mov_b32 s35, 1
    s_nop 7
    s_nop 7
    s_branch K_NORM
K_LAST:
.section .rodata,"a"
.p2align 6
.amdhsa_kernel parallel_sum__mha_block__dense_activation_relu__prompt_kernel
  .amdhsa_next_free_vgpr 256
  .amdhsa_next_free_sgpr 64
  .amdhsa_accum_offset 256
  .amdhsa_group_segment_fixed_size 0
  .amdhsa_kernarg_size 72
  .amdhsa_user_sgpr_count 2
  .amdhsa_user_sgpr_kernarg_segment_ptr 1
  .amdhsa_system_sgpr_workgroup_id_x 1
.end_amdhsa_kernel
```
